```python
import torch

def _softmax(x, axis=-1):
    return torch.softmax(x, dim=axis)
def _gelu(x):
    return torch.nn.functional.gelu(x, approximate="tanh")
def _silu(x):
    return torch.nn.functional.silu(x)
def _sigmoid(x):
    return torch.sigmoid(x)
def _layernorm(x, axis=-1, eps=1e-5):
    m = x.mean(dim=axis, keepdim=True)
    v = x.var(dim=axis, keepdim=True, unbiased=False)
    return (x - m) / torch.sqrt(v + eps)
def _scatter_add(tgt, idx, src, axis=0):
    return tgt.clone().index_add_(axis, idx, src)
def _segment_sum(src, seg, n):
    out = torch.zeros((n,) + src.shape[1:], dtype=src.dtype)
    return out.index_add_(0, seg, src)
def _pad(x, pw):
    flat = tuple(v for pair in reversed(pw) for v in pair)
    return torch.nn.functional.pad(x, flat)

kernel_name = 'standalone__deep_cross_pnn__recsys'

def setup_inputs():

    _w = (lambda a: (lambda t: t.to(torch.bfloat16) if t.is_floating_point() else t)(torch.as_tensor(a)))
    B, F, D, V = 4096, 100, 128, min(1000, 100000)
    H = 4 * D
    return {
        "idx": _w((lambda lo, hi, *s: torch.randint(lo, hi, s))(0, V, B, F).to(torch.int64)),
        "table": _w((lambda *s: torch.randn(*s, dtype=torch.bfloat16) * 1.6)(V, D) * (D ** -0.5)),
        "w_p": _w((lambda *s: torch.randn(*s, dtype=torch.bfloat16) * 0.05)(F * F) * ((F * F) ** -0.5)),
        "w1": _w((lambda *s: torch.randn(*s, dtype=torch.bfloat16) * 1.6)(F * D, H) * ((F * D) ** -0.5)),
        "b1": _w((lambda *s: torch.randn(*s, dtype=torch.bfloat16) * 6.4)(H) * 0.01),
        "w2": _w((lambda *s: torch.randn(*s, dtype=torch.bfloat16) * 0.05)(H) * (H ** -0.5)),
        "b2": _w((lambda *s: torch.randn(*s, dtype=torch.bfloat16) * 0.8)(1) * 0.01),
    }

def reference(idx, table, w_p, w1, b1, w2, b2):
    emb = table[idx]
    B = emb.shape[0]; F = emb.shape[1]; D = emb.shape[2]
    ip = torch.einsum('bid,bjd->bij', emb, emb)
    ip = ip.reshape(B, F * F)
    logit_p = ip @ w_p
    z = emb.reshape(B, F * D)
    h = _gelu(z @ w1 + b1)
    logit_d = h @ w2 + b2
    return logit_p + logit_d
```

```asm
; @launch grid=(256,1,1) block=(256,1,1) lds=163840
.amdgcn_target "amdgcn-amd-amdhsa--gfx950"
.text
.globl standalone__deep_cross_pnn__recsys_kernel
.p2align 8
.type standalone__deep_cross_pnn__recsys_kernel,@function
standalone__deep_cross_pnn__recsys_kernel:
s_cmp_ge_u32 s2, 256
s_cbranch_scc1 L_END
s_load_dwordx16 s[64:79], s[0:1], 0
s_load_dwordx4 s[80:83], s[0:1], 64
v_lshrrev_b32 v6, 6, v0
v_and_b32 v7, 63, v0
s_getpc_b64 s[28:29]
L_PC:
s_mov_b32 s30, L_CODE_END-L_PC
s_mov_b32 s31, 0x20000
v_lshrrev_b32 v47, 3, v0
v_lshlrev_b32 v46, 7, v0
v_lshl_add_u32 v46, v47, 20, v46
s_lshr_b32 s44, s2, 3
s_lshl_b32 s44, s44, 10
buffer_load_dword v47, v46, s[28:31], s44 offen
v_readfirstlane_b32 s3, v6
s_and_b32 s36, s2, 7
s_lshl_b32 s36, s36, 3
s_bfe_u32 s37, s2, 0x30003
s_add_u32 s36, s36, s37
s_lshr_b32 s37, s2, 6
s_lshr_b32 s40, s2, 2
s_and_b32 s41, s2, 3
v_lshlrev_b32 v5, 4, v7
s_lshl_b32 s38, s36, 4
s_lshl_b32 s39, s3, 17
s_add_u32 s38, s38, s39
v_lshl_add_u32 v4, v7, 10, s38
s_mul_i32 s45, s37, 24*131072
s_add_u32 s46, s45, 24*131072
s_mul_i32 s47, s3, 2112
s_add_u32 s47, s47, 131072
s_add_u32 s48, s47, 25344
s_mov_b32 s49, s3
v_and_b32 v44, 15, v7
v_lshrrev_b32 v45, 4, v7
v_add_u32 v40, 0, v45
v_xor_b32 v40, v40, v44
v_lshlrev_b32 v40, 4, v40
v_lshl_add_u32 v40, v45, 8, v40
v_add_u32 v41, 4, v45
v_xor_b32 v41, v41, v44
v_lshlrev_b32 v41, 4, v41
v_lshl_add_u32 v41, v45, 8, v41
v_add_u32 v42, 8, v45
v_xor_b32 v42, v42, v44
v_lshlrev_b32 v42, 4, v42
v_lshl_add_u32 v42, v45, 8, v42
v_add_u32 v43, 12, v45
v_xor_b32 v43, v43, v44
v_lshlrev_b32 v43, 4, v43
v_lshl_add_u32 v43, v45, 8, v43
s_lshl_b32 s50, s3, 16
s_lshl_b32 s51, s3, 14
v_lshlrev_b32 v46, 7, v7
s_waitcnt lgkmcnt(0)
s_cmp_ge_u32 s3, 2
s_cbranch_scc1 L_loader
s_mov_b32 s4, s64
s_mov_b32 s5, s65
s_mov_b32 s6, 1638400
s_mov_b32 s7, 0x20000
s_lshl_b32 s42, s3, 2
v_bfe_u32 v148, v7, 2, 2
v_add_u32 v148, s42, v148
s_mul_i32 s42, s41, 96
s_lshl_b32 s43, s3, 6
s_add_u32 s42, s42, s43
v_lshl_add_u32 v144, v44, 2, s42
v_and_b32 v145, 3, v7
v_lshlrev_b32 v145, 2, v145
v_add_u32 v145, 384, v145
v_cmp_gt_u32 vcc, 6, v148
s_mul_i32 s43, s40, 64*400
s_nop 0
v_cndmask_b32 v144, v145, v144, vcc
v_lshrrev_b32 v145, 5, v7
v_lshlrev_b32 v145, 5, v145
v_bfe_u32 v149, v7, 4, 1
v_add_u32 v145, v145, v149
v_mul_u32_u24 v145, 400, v145
v_add_u32 v144, v144, v145
v_mov_b32 v145, 0x7ffffff0
v_cmp_gt_u32 vcc, 7, v148
s_nop 1
v_cndmask_b32 v144, v145, v144, vcc
buffer_load_dword v128, v144, s[4:7], s43 offen offset:0
buffer_load_dword v129, v144, s[4:7], s43 offen offset:800
buffer_load_dword v130, v144, s[4:7], s43 offen offset:1600
buffer_load_dword v131, v144, s[4:7], s43 offen offset:2400
s_add_u32 s43, s43, 3200
buffer_load_dword v132, v144, s[4:7], s43 offen offset:0
buffer_load_dword v133, v144, s[4:7], s43 offen offset:800
buffer_load_dword v134, v144, s[4:7], s43 offen offset:1600
buffer_load_dword v135, v144, s[4:7], s43 offen offset:2400
s_add_u32 s43, s43, 3200
buffer_load_dword v136, v144, s[4:7], s43 offen offset:0
buffer_load_dword v137, v144, s[4:7], s43 offen offset:800
buffer_load_dword v138, v144, s[4:7], s43 offen offset:1600
buffer_load_dword v139, v144, s[4:7], s43 offen offset:2400
s_add_u32 s43, s43, 3200
buffer_load_dword v140, v144, s[4:7], s43 offen offset:0
buffer_load_dword v141, v144, s[4:7], s43 offen offset:800
buffer_load_dword v142, v144, s[4:7], s43 offen offset:1600
buffer_load_dword v143, v144, s[4:7], s43 offen offset:2400
s_mov_b32 s8, s66
s_mov_b32 s9, s67
s_mov_b32 s10, 256000
s_mov_b32 s11, 0x20000
s_mov_b32 s12, s70
s_mov_b32 s13, s71
s_mov_b32 s14, 13107200
s_mov_b32 s15, 0x20000
s_mov_b32 s24, s80
s_mov_b32 s25, s81
s_mov_b32 s26, 256
s_mov_b32 s27, 0x20000
s_mov_b32 s28, s68
s_mov_b32 s29, s69
s_mov_b32 s30, 20000
s_mov_b32 s31, 0x20000
v_mov_b32 v49, 0x7ff00000
v_cmp_gt_u32 vcc, 3, v7
s_lshr_b32 s44, s2, 3
s_lshl_b32 s44, s44, 1
s_add_u32 s44, s44, s3
s_mul_i32 s44, s44, 384
v_cndmask_b32 v48, v49, v46, vcc
buffer_load_dword v47, v48, s[28:31], s44 offen
s_mov_b32 s28, s72
s_mov_b32 s29, s73
s_mov_b32 s30, 1024
s_mov_b32 s31, 0x20000
buffer_load_ushort v47, v46, s[28:31], 0 offen
s_mov_b32 s28, s74
s_mov_b32 s29, s75
s_mov_b32 s30, 1024
s_mov_b32 s31, 0x20000
buffer_load_ushort v47, v46, s[28:31], 0 offen
s_mov_b32 s28, s76
s_mov_b32 s29, s77
s_mov_b32 s30, 2
s_mov_b32 s31, 0x20000
buffer_load_ushort v47, v46, s[28:31], 0 offen
s_cmp_lt_u32 s2, 8
s_cselect_b32 s44, s3, 0
s_cmp_eq_u32 s44, 1
s_cbranch_scc0 L_nn
s_memrealtime s[42:43]
s_waitcnt lgkmcnt(0)
s_or_b32 s42, s42, 1
v_mov_b32 v48, s42
v_mov_b32 v49, 0
v_lshlrev_b32 v50, 20, v7
buffer_atomic_cmpswap v[48:49], v50, s[24:27], 0 offen sc1
L_nn:
s_mov_b32 s16, s82
s_mov_b32 s17, s83
s_mov_b32 s18, 819200
s_mov_b32 s19, 0x20000
s_add_u32 s20, s82, 2097152
s_addc_u32 s21, s83, 0
s_mov_b32 s22, 16777216
s_mov_b32 s23, 0x20000
s_add_u32 s32, s82, 1048576
s_addc_u32 s33, s83, 0
s_mov_b32 s34, 8192
s_mov_b32 s35, 0x20000
v_and_b32 v13, 31, v7
v_lshrrev_b32 v14, 2, v13
v_and_b32 v13, 3, v13
v_lshlrev_b32 v13, 4, v13
v_lshl_add_u32 v13, v14, 8, v13
v_lshrrev_b32 v15, 5, v7
v_lshl_add_u32 v13, v15, 7, v13
v_lshl_add_u32 v13, v6, 14, v13
v_and_b32 v14, 1, v14
v_lshl_add_u32 v1, v14, 6, v13
v_xor_b32 v2, 64, v1
v_xor_b32 v13, v44, v15
v_lshlrev_b32 v13, 4, v13
v_and_b32 v14, 31, v7
v_lshl_add_u32 v13, v14, 8, v13
v_lshl_add_u32 v32, v6, 14, v13
v_xor_b32 v33, 32, v32
v_xor_b32 v34, 64, v32
v_xor_b32 v35, 96, v32
v_xor_b32 v36, 128, v32
v_xor_b32 v37, 160, v32
v_xor_b32 v38, 192, v32
v_xor_b32 v39, 224, v32
v_xor_b32 v56, 0x10000, v32
v_xor_b32 v57, 0x10000, v33
v_xor_b32 v58, 0x10000, v34
v_xor_b32 v59, 0x10000, v35
v_xor_b32 v60, 0x10000, v36
v_xor_b32 v61, 0x10000, v37
v_xor_b32 v62, 0x10000, v38
v_xor_b32 v63, 0x10000, v39
v_and_b32 v13, 1, v7
v_bfe_u32 v14, v7, 4, 1
v_lshl_add_u32 v13, v13, 1, v14
v_mul_u32_u24 v13, 2112, v13
v_bfe_u32 v14, v7, 2, 2
v_lshl_add_u32 v14, v15, 3, v14
v_lshl_add_u32 v13, v14, 4, v13
v_bfe_u32 v14, v7, 1, 1
v_lshl_add_u32 v13, v14, 3, v13
v_add_u32 v3, 131072, v13
v_mov_b32 v15, v3
v_bfe_u32 v13, v7, 4, 1
v_bfe_u32 v14, v7, 3, 1
v_cmp_eq_u32 vcc, v13, v14
v_mov_b32 v13, 0x3f80
v_bfe_u32 v14, v7, 2, 1
v_cndmask_b32 v13, 0, v13, vcc
v_cmp_eq_u32 vcc, 0, v14
s_nop 1
v_cndmask_b32 v8, 0, v13, vcc
v_xor_b32 v9, v8, v13
v_mov_b32 v10, v8
v_mov_b32 v11, v9
v_and_b32 v13, 3, v7
v_mul_u32_u24 v12, 0x5555, v13
s_mov_b32 s53, 0x110000
s_mov_b32 s54, 0
s_lshl_b32 s55, s37, 2
s_add_u32 s55, s55, s3
s_mul_i32 s55, s55, 51200
s_mov_b32 s60, s2
s_mov_b32 s61, 0
v_mov_b32 v50, 0
v_and_b32 v146, 3, v7
v_lshlrev_b32 v147, 6, v146
v_lshrrev_b32 v155, 2, v7
s_lshl_b32 s42, s3, 10
s_add_u32 s42, s42, 160256
v_lshl_add_u32 v149, v155, 6, s42
v_add_u32 v156, s42, v5
v_mov_b64 v[160:161], 0
v_mov_b64 v[162:163], 0
ds_write_b128 v156, v[160:163]
v_mul_u32_u24 v150, 0x010101, v146
v_lshl_or_b32 v150, v146, 24, v150
v_xor_b32 v150, 0x03020100, v150
v_cmp_gt_u32 vcc, 7, v148
v_mov_b32 v156, 0x4000
v_lshlrev_b32 v151, 2, v45
v_cndmask_b32 v155, v156, v148, vcc
v_lshl_add_u32 v151, v155, 9, v151
v_add_u32 v151, 156672, v151
v_xor_b32 v152, 0x100, v151
s_mov_b32 s62, 0x24100400
s_mov_b32 s63, 0x102
v_mov_b32 v153, 0x3c3c3c3c
v_mov_b32 v154, 0x101
v_xor_b32 v167, 1, v146
s_waitcnt vmcnt(4)
v_and_b32 v155, 7, v128
v_lshrrev_b32 v128, 2, v128
v_lshlrev_b32 v155, 4, v155
v_xor_b32 v155, v155, v147
v_lshl_add_u32 v128, v128, 8, v155
v_lshrrev_b32 v155, 2, v155
v_add_u32 v176, v155, v149
v_xor_b32 v157, 0, v146
v_lshlrev_b32 v158, 3, v157
v_lshlrev_b32 v158, v158, 1
ds_add_u32 v176, v158
v_mul_u32_u24 v157, v157, v154
v_bitop3_b32 v157, v157, s63, v151 bitop3:0x6a
ds_write_b16 v157, v128 offset:0
v_and_b32 v155, 7, v129
v_lshrrev_b32 v129, 2, v129
v_lshlrev_b32 v155, 4, v155
v_xor_b32 v155, v155, v147
v_lshl_add_u32 v129, v129, 8, v155
v_lshrrev_b32 v155, 2, v155
v_add_u32 v177, v155, v149
v_xor_b32 v165, 1, v146
v_lshlrev_b32 v166, 3, v165
v_lshlrev_b32 v166, v166, 1
ds_add_u32 v177, v166
v_mul_u32_u24 v165, v165, v154
v_bitop3_b32 v165, v165, s63, v151 bitop3:0x6a
ds_write_b16 v165, v129 offset:16
v_and_b32 v155, 7, v130
v_lshrrev_b32 v130, 2, v130
v_lshlrev_b32 v155, 4, v155
v_xor_b32 v155, v155, v147
v_lshl_add_u32 v130, v130, 8, v155
v_lshrrev_b32 v155, 2, v155
v_add_u32 v178, v155, v149
v_xor_b32 v157, 2, v146
v_lshlrev_b32 v158, 3, v157
v_lshlrev_b32 v158, v158, 1
ds_add_u32 v178, v158
v_mul_u32_u24 v157, v157, v154
v_bitop3_b32 v157, v157, s63, v151 bitop3:0x6a
ds_write_b16 v157, v130 offset:32
v_and_b32 v155, 7, v131
v_lshrrev_b32 v131, 2, v131
v_lshlrev_b32 v155, 4, v155
v_xor_b32 v155, v155, v147
v_lshl_add_u32 v131, v131, 8, v155
v_lshrrev_b32 v155, 2, v155
v_add_u32 v179, v155, v149
v_xor_b32 v165, 3, v146
v_lshlrev_b32 v166, 3, v165
v_lshlrev_b32 v166, v166, 1
ds_add_u32 v179, v166
v_mul_u32_u24 v165, v165, v154
v_bitop3_b32 v165, v165, s63, v151 bitop3:0x6a
ds_write_b16 v165, v131 offset:48
v_and_b32 v155, 7, v132
v_lshrrev_b32 v132, 2, v132
v_lshlrev_b32 v155, 4, v155
v_xor_b32 v155, v155, v147
v_lshl_add_u32 v132, v132, 8, v155
v_lshrrev_b32 v155, 2, v155
v_add_u32 v180, v155, v149
v_and_b32 v155, 7, v133
v_lshrrev_b32 v133, 2, v133
v_lshlrev_b32 v155, 4, v155
v_xor_b32 v155, v155, v147
v_lshl_add_u32 v133, v133, 8, v155
v_lshrrev_b32 v155, 2, v155
v_add_u32 v181, v155, v149
ds_read_b32 v156, v180
ds_read_b32 v164, v181
v_and_b32 v155, 7, v134
v_lshrrev_b32 v134, 2, v134
v_lshlrev_b32 v155, 4, v155
v_xor_b32 v155, v155, v147
v_lshl_add_u32 v134, v134, 8, v155
v_lshrrev_b32 v155, 2, v155
v_add_u32 v182, v155, v149
v_and_b32 v155, 7, v135
v_lshrrev_b32 v135, 2, v135
v_lshlrev_b32 v155, 4, v155
v_xor_b32 v155, v155, v147
v_lshl_add_u32 v135, v135, 8, v155
v_lshrrev_b32 v155, 2, v155
v_add_u32 v183, v155, v149
s_waitcnt lgkmcnt(0)
v_perm_b32 v156, v153, s62, v156
v_perm_b32 v164, v153, s62, v164
v_perm_b32 v156, v156, v156, v150
v_perm_b32 v164, v164, v164, v150
s_nop 0
v_add_u32_dpp v156, v156, v156 quad_perm:[1,0,3,2] row_mask:0xf bank_mask:0xf
v_add_u32_dpp v164, v164, v164 quad_perm:[1,0,3,2] row_mask:0xf bank_mask:0xf
s_nop 0
v_add_u32_dpp v156, v156, v156 quad_perm:[2,3,0,1] row_mask:0xf bank_mask:0xf
v_add_u32_dpp v164, v164, v164 quad_perm:[2,3,0,1] row_mask:0xf bank_mask:0xf
v_add_u32 v156, 50462976, v156
v_add_u32 v164, 33751041, v164
v_min_u32_sdwa v157, v156, v156 dst_sel:DWORD dst_unused:UNUSED_PAD src0_sel:BYTE_0 src1_sel:BYTE_1
v_min_u32_sdwa v165, v164, v164 dst_sel:DWORD dst_unused:UNUSED_PAD src0_sel:BYTE_0 src1_sel:BYTE_1
v_min_u32_sdwa v158, v156, v156 dst_sel:DWORD dst_unused:UNUSED_PAD src0_sel:BYTE_2 src1_sel:BYTE_3
v_min_u32_sdwa v166, v164, v164 dst_sel:DWORD dst_unused:UNUSED_PAD src0_sel:BYTE_2 src1_sel:BYTE_3
v_min_u32 v157, v157, v158
v_min_u32 v165, v165, v166
v_bitop3_b32 v157, v157, 3, v146 bitop3:0x6a
v_bitop3_b32 v165, v165, 3, v167 bitop3:0x6a
v_lshlrev_b32 v158, 3, v157
v_lshlrev_b32 v158, v158, 1
ds_add_u32 v180, v158
v_lshlrev_b32 v166, 3, v165
v_lshlrev_b32 v166, v166, 1
ds_add_u32 v181, v166
ds_read_b32 v156, v182
ds_read_b32 v164, v183
buffer_load_dword v51, v50, s[24:27], 0 offen sc1
v_mul_u32_u24 v157, v157, v154
v_bitop3_b32 v157, v157, s63, v152 bitop3:0x6a
ds_write_b16 v157, v132 offset:64
v_mul_u32_u24 v165, v165, v154
v_bitop3_b32 v165, v165, s63, v152 bitop3:0x6a
ds_write_b16 v165, v133 offset:80
v_and_b32 v155, 7, v136
v_lshrrev_b32 v136, 2, v136
v_lshlrev_b32 v155, 4, v155
v_xor_b32 v155, v155, v147
v_lshl_add_u32 v136, v136, 8, v155
v_lshrrev_b32 v155, 2, v155
v_add_u32 v184, v155, v149
v_and_b32 v155, 7, v137
v_lshrrev_b32 v137, 2, v137
v_lshlrev_b32 v155, 4, v155
v_xor_b32 v155, v155, v147
v_lshl_add_u32 v137, v137, 8, v155
v_lshrrev_b32 v155, 2, v155
v_add_u32 v185, v155, v149
s_waitcnt lgkmcnt(2)
v_perm_b32 v156, v153, s62, v156
v_perm_b32 v164, v153, s62, v164
v_perm_b32 v156, v156, v156, v150
v_perm_b32 v164, v164, v164, v150
s_nop 0
v_add_u32_dpp v156, v156, v156 quad_perm:[1,0,3,2] row_mask:0xf bank_mask:0xf
v_add_u32_dpp v164, v164, v164 quad_perm:[1,0,3,2] row_mask:0xf bank_mask:0xf
s_nop 0
v_add_u32_dpp v156, v156, v156 quad_perm:[2,3,0,1] row_mask:0xf bank_mask:0xf
v_add_u32_dpp v164, v164, v164 quad_perm:[2,3,0,1] row_mask:0xf bank_mask:0xf
v_add_u32 v156, 50462976, v156
v_add_u32 v164, 33751041, v164
v_min_u32_sdwa v157, v156, v156 dst_sel:DWORD dst_unused:UNUSED_PAD src0_sel:BYTE_0 src1_sel:BYTE_1
v_min_u32_sdwa v165, v164, v164 dst_sel:DWORD dst_unused:UNUSED_PAD src0_sel:BYTE_0 src1_sel:BYTE_1
v_min_u32_sdwa v158, v156, v156 dst_sel:DWORD dst_unused:UNUSED_PAD src0_sel:BYTE_2 src1_sel:BYTE_3
v_min_u32_sdwa v166, v164, v164 dst_sel:DWORD dst_unused:UNUSED_PAD src0_sel:BYTE_2 src1_sel:BYTE_3
v_min_u32 v157, v157, v158
v_min_u32 v165, v165, v166
v_bitop3_b32 v157, v157, 3, v146 bitop3:0x6a
v_bitop3_b32 v165, v165, 3, v167 bitop3:0x6a
v_lshlrev_b32 v158, 3, v157
v_lshlrev_b32 v158, v158, 1
ds_add_u32 v182, v158
v_lshlrev_b32 v166, 3, v165
v_lshlrev_b32 v166, v166, 1
ds_add_u32 v183, v166
ds_read_b32 v156, v184
ds_read_b32 v164, v185
v_mul_u32_u24 v157, v157, v154
v_bitop3_b32 v157, v157, s63, v152 bitop3:0x6a
ds_write_b16 v157, v134 offset:96
v_mul_u32_u24 v165, v165, v154
v_bitop3_b32 v165, v165, s63, v152 bitop3:0x6a
ds_write_b16 v165, v135 offset:112
v_and_b32 v155, 7, v138
v_lshrrev_b32 v138, 2, v138
v_lshlrev_b32 v155, 4, v155
v_xor_b32 v155, v155, v147
v_lshl_add_u32 v138, v138, 8, v155
v_lshrrev_b32 v155, 2, v155
v_add_u32 v186, v155, v149
v_and_b32 v155, 7, v139
v_lshrrev_b32 v139, 2, v139
v_lshlrev_b32 v155, 4, v155
v_xor_b32 v155, v155, v147
v_lshl_add_u32 v139, v139, 8, v155
v_lshrrev_b32 v155, 2, v155
v_add_u32 v187, v155, v149
s_waitcnt lgkmcnt(2)
v_perm_b32 v156, v153, s62, v156
v_perm_b32 v164, v153, s62, v164
v_perm_b32 v156, v156, v156, v150
v_perm_b32 v164, v164, v164, v150
s_nop 0
v_add_u32_dpp v156, v156, v156 quad_perm:[1,0,3,2] row_mask:0xf bank_mask:0xf
v_add_u32_dpp v164, v164, v164 quad_perm:[1,0,3,2] row_mask:0xf bank_mask:0xf
s_nop 0
v_add_u32_dpp v156, v156, v156 quad_perm:[2,3,0,1] row_mask:0xf bank_mask:0xf
v_add_u32_dpp v164, v164, v164 quad_perm:[2,3,0,1] row_mask:0xf bank_mask:0xf
v_add_u32 v156, 50462976, v156
v_add_u32 v164, 33751041, v164
v_min_u32_sdwa v157, v156, v156 dst_sel:DWORD dst_unused:UNUSED_PAD src0_sel:BYTE_0 src1_sel:BYTE_1
v_min_u32_sdwa v165, v164, v164 dst_sel:DWORD dst_unused:UNUSED_PAD src0_sel:BYTE_0 src1_sel:BYTE_1
v_min_u32_sdwa v158, v156, v156 dst_sel:DWORD dst_unused:UNUSED_PAD src0_sel:BYTE_2 src1_sel:BYTE_3
v_min_u32_sdwa v166, v164, v164 dst_sel:DWORD dst_unused:UNUSED_PAD src0_sel:BYTE_2 src1_sel:BYTE_3
v_min_u32 v157, v157, v158
v_min_u32 v165, v165, v166
v_bitop3_b32 v157, v157, 3, v146 bitop3:0x6a
v_bitop3_b32 v165, v165, 3, v167 bitop3:0x6a
v_lshlrev_b32 v158, 3, v157
v_lshlrev_b32 v158, v158, 1
ds_add_u32 v184, v158
v_lshlrev_b32 v166, 3, v165
v_lshlrev_b32 v166, v166, 1
ds_add_u32 v185, v166
ds_read_b32 v156, v186
ds_read_b32 v164, v187
v_mul_u32_u24 v157, v157, v154
v_bitop3_b32 v157, v157, s63, v152 bitop3:0x6a
ds_write_b16 v157, v136 offset:128
v_mul_u32_u24 v165, v165, v154
v_bitop3_b32 v165, v165, s63, v152 bitop3:0x6a
ds_write_b16 v165, v137 offset:144
v_and_b32 v155, 7, v140
v_lshrrev_b32 v140, 2, v140
v_lshlrev_b32 v155, 4, v155
v_xor_b32 v155, v155, v147
v_lshl_add_u32 v140, v140, 8, v155
v_lshrrev_b32 v155, 2, v155
v_add_u32 v188, v155, v149
v_and_b32 v155, 7, v141
v_lshrrev_b32 v141, 2, v141
v_lshlrev_b32 v155, 4, v155
v_xor_b32 v155, v155, v147
v_lshl_add_u32 v141, v141, 8, v155
v_lshrrev_b32 v155, 2, v155
v_add_u32 v189, v155, v149
s_waitcnt lgkmcnt(2)
v_perm_b32 v156, v153, s62, v156
v_perm_b32 v164, v153, s62, v164
v_perm_b32 v156, v156, v156, v150
v_perm_b32 v164, v164, v164, v150
s_nop 0
v_add_u32_dpp v156, v156, v156 quad_perm:[1,0,3,2] row_mask:0xf bank_mask:0xf
v_add_u32_dpp v164, v164, v164 quad_perm:[1,0,3,2] row_mask:0xf bank_mask:0xf
s_nop 0
v_add_u32_dpp v156, v156, v156 quad_perm:[2,3,0,1] row_mask:0xf bank_mask:0xf
v_add_u32_dpp v164, v164, v164 quad_perm:[2,3,0,1] row_mask:0xf bank_mask:0xf
v_add_u32 v156, 50462976, v156
v_add_u32 v164, 33751041, v164
v_min_u32_sdwa v157, v156, v156 dst_sel:DWORD dst_unused:UNUSED_PAD src0_sel:BYTE_0 src1_sel:BYTE_1
v_min_u32_sdwa v165, v164, v164 dst_sel:DWORD dst_unused:UNUSED_PAD src0_sel:BYTE_0 src1_sel:BYTE_1
v_min_u32_sdwa v158, v156, v156 dst_sel:DWORD dst_unused:UNUSED_PAD src0_sel:BYTE_2 src1_sel:BYTE_3
v_min_u32_sdwa v166, v164, v164 dst_sel:DWORD dst_unused:UNUSED_PAD src0_sel:BYTE_2 src1_sel:BYTE_3
v_min_u32 v157, v157, v158
v_min_u32 v165, v165, v166
v_bitop3_b32 v157, v157, 3, v146 bitop3:0x6a
v_bitop3_b32 v165, v165, 3, v167 bitop3:0x6a
v_lshlrev_b32 v158, 3, v157
v_lshlrev_b32 v158, v158, 1
ds_add_u32 v186, v158
v_lshlrev_b32 v166, 3, v165
v_lshlrev_b32 v166, v166, 1
ds_add_u32 v187, v166
ds_read_b32 v156, v188
ds_read_b32 v164, v189
v_mul_u32_u24 v157, v157, v154
v_bitop3_b32 v157, v157, s63, v152 bitop3:0x6a
ds_write_b16 v157, v138 offset:160
v_mul_u32_u24 v165, v165, v154
v_bitop3_b32 v165, v165, s63, v152 bitop3:0x6a
ds_write_b16 v165, v139 offset:176
v_and_b32 v155, 7, v142
v_lshrrev_b32 v142, 2, v142
v_lshlrev_b32 v155, 4, v155
v_xor_b32 v155, v155, v147
v_lshl_add_u32 v142, v142, 8, v155
v_lshrrev_b32 v155, 2, v155
v_add_u32 v190, v155, v149
v_and_b32 v155, 7, v143
v_lshrrev_b32 v143, 2, v143
v_lshlrev_b32 v155, 4, v155
v_xor_b32 v155, v155, v147
v_lshl_add_u32 v143, v143, 8, v155
v_lshrrev_b32 v155, 2, v155
v_add_u32 v191, v155, v149
s_waitcnt lgkmcnt(2)
v_perm_b32 v156, v153, s62, v156
v_perm_b32 v164, v153, s62, v164
v_perm_b32 v156, v156, v156, v150
v_perm_b32 v164, v164, v164, v150
s_nop 0
v_add_u32_dpp v156, v156, v156 quad_perm:[1,0,3,2] row_mask:0xf bank_mask:0xf
v_add_u32_dpp v164, v164, v164 quad_perm:[1,0,3,2] row_mask:0xf bank_mask:0xf
s_nop 0
v_add_u32_dpp v156, v156, v156 quad_perm:[2,3,0,1] row_mask:0xf bank_mask:0xf
v_add_u32_dpp v164, v164, v164 quad_perm:[2,3,0,1] row_mask:0xf bank_mask:0xf
v_add_u32 v156, 50462976, v156
v_add_u32 v164, 33751041, v164
v_min_u32_sdwa v157, v156, v156 dst_sel:DWORD dst_unused:UNUSED_PAD src0_sel:BYTE_0 src1_sel:BYTE_1
v_min_u32_sdwa v165, v164, v164 dst_sel:DWORD dst_unused:UNUSED_PAD src0_sel:BYTE_0 src1_sel:BYTE_1
v_min_u32_sdwa v158, v156, v156 dst_sel:DWORD dst_unused:UNUSED_PAD src0_sel:BYTE_2 src1_sel:BYTE_3
v_min_u32_sdwa v166, v164, v164 dst_sel:DWORD dst_unused:UNUSED_PAD src0_sel:BYTE_2 src1_sel:BYTE_3
v_min_u32 v157, v157, v158
v_min_u32 v165, v165, v166
v_bitop3_b32 v157, v157, 3, v146 bitop3:0x6a
v_bitop3_b32 v165, v165, 3, v167 bitop3:0x6a
v_lshlrev_b32 v158, 3, v157
v_lshlrev_b32 v158, v158, 1
ds_add_u32 v188, v158
v_lshlrev_b32 v166, 3, v165
v_lshlrev_b32 v166, v166, 1
ds_add_u32 v189, v166
ds_read_b32 v156, v190
ds_read_b32 v164, v191
v_mul_u32_u24 v157, v157, v154
v_bitop3_b32 v157, v157, s63, v151 bitop3:0x6a
ds_write_b16 v157, v140 offset:192
v_mul_u32_u24 v165, v165, v154
v_bitop3_b32 v165, v165, s63, v151 bitop3:0x6a
ds_write_b16 v165, v141 offset:208
s_waitcnt lgkmcnt(2)
v_perm_b32 v156, v153, s62, v156
v_perm_b32 v164, v153, s62, v164
v_perm_b32 v156, v156, v156, v150
v_perm_b32 v164, v164, v164, v150
s_nop 0
v_add_u32_dpp v156, v156, v156 quad_perm:[1,0,3,2] row_mask:0xf bank_mask:0xf
v_add_u32_dpp v164, v164, v164 quad_perm:[1,0,3,2] row_mask:0xf bank_mask:0xf
s_nop 0
v_add_u32_dpp v156, v156, v156 quad_perm:[2,3,0,1] row_mask:0xf bank_mask:0xf
v_add_u32_dpp v164, v164, v164 quad_perm:[2,3,0,1] row_mask:0xf bank_mask:0xf
v_add_u32 v156, 50462976, v156
v_add_u32 v164, 33751041, v164
v_min_u32_sdwa v157, v156, v156 dst_sel:DWORD dst_unused:UNUSED_PAD src0_sel:BYTE_0 src1_sel:BYTE_1
v_min_u32_sdwa v165, v164, v164 dst_sel:DWORD dst_unused:UNUSED_PAD src0_sel:BYTE_0 src1_sel:BYTE_1
v_min_u32_sdwa v158, v156, v156 dst_sel:DWORD dst_unused:UNUSED_PAD src0_sel:BYTE_2 src1_sel:BYTE_3
v_min_u32_sdwa v166, v164, v164 dst_sel:DWORD dst_unused:UNUSED_PAD src0_sel:BYTE_2 src1_sel:BYTE_3
v_min_u32 v157, v157, v158
v_min_u32 v165, v165, v166
v_bitop3_b32 v157, v157, 3, v146 bitop3:0x6a
v_bitop3_b32 v165, v165, 3, v167 bitop3:0x6a
v_lshlrev_b32 v158, 3, v157
v_lshlrev_b32 v158, v158, 1
ds_add_u32 v190, v158
v_lshlrev_b32 v166, 3, v165
v_lshlrev_b32 v166, v166, 1
ds_add_u32 v191, v166
v_mul_u32_u24 v157, v157, v154
v_bitop3_b32 v157, v157, s63, v151 bitop3:0x6a
ds_write_b16 v157, v142 offset:224
v_mul_u32_u24 v165, v165, v154
v_bitop3_b32 v165, v165, s63, v151 bitop3:0x6a
ds_write_b16 v165, v143 offset:240
s_waitcnt lgkmcnt(0)
s_lshl_b32 s42, s3, 11
s_add_u32 s42, s42, 156672
v_add_u32 v144, s42, v5
ds_read_b128 v[128:131], v144 offset:0
ds_read_b128 v[132:135], v144 offset:1024
s_lshr_b32 s42, s40, 4
s_lshl_b32 s43, s41, 2
s_add_u32 s42, s42, s43
s_mul_i32 s42, s42, 50
s_lshr_b32 s43, s40, 1
s_lshl_b32 s44, s41, 1
s_sub_u32 s43, s43, s44
s_sub_u32 s43, s43, 2
s_and_b32 s43, s43, 7
s_add_u32 s42, s42, s43
s_lshl_b32 s42, s42, 10
s_and_b32 s44, s40, 1
s_lshl_b32 s44, s44, 9
s_add_u32 s42, s42, s44
s_lshl_b32 s44, s3, 15
s_add_u32 s42, s42, s44
v_and_b32 v145, 31, v7
v_lshlrev_b32 v145, 4, v145
v_lshrrev_b32 v146, 5, v7
v_lshl_add_u32 v145, v146, 13, v145
s_cmp_ge_u32 s43, 6
s_cselect_b32 s44, 32, 0
s_cmp_eq_u32 s3, 0
s_cselect_b32 s44, 64, s44
s_cselect_b32 s43, 0, 6144
v_cmp_gt_u32 vcc, s44, v7
v_mov_b32 v146, 0x7ffffff0
s_waitcnt lgkmcnt(0)
v_cndmask_b32 v146, v146, v145, vcc
buffer_store_dwordx4 v[128:131], v145, s[16:19], s42 offen sc1
s_add_u32 s42, s42, 16384
s_sub_u32 s42, s42, s43
buffer_store_dwordx4 v[132:135], v146, s[16:19], s42 offen sc1
s_add_u32 m0, s51, 8192
s_add_u32 s52, s50, 8192
buffer_load_dwordx4 v40, s[8:11], s52 offen offset:0 lds
buffer_load_dwordx4 v41, s[8:11], s52 offen offset:1024 lds
s_add_u32 m0, s51, 8192
s_add_u32 s52, s50, 8192
buffer_load_dwordx4 v42, s[8:11], s52 offen offset:2048 lds
buffer_load_dwordx4 v43, s[8:11], s52 offen offset:3072 lds
s_add_u32 m0, s51, 12288
s_add_u32 s52, s50, 12288
buffer_load_dwordx4 v40, s[8:11], s52 offen offset:0 lds
buffer_load_dwordx4 v41, s[8:11], s52 offen offset:1024 lds
s_add_u32 m0, s51, 12288
s_add_u32 s52, s50, 12288
buffer_load_dwordx4 v42, s[8:11], s52 offen offset:2048 lds
buffer_load_dwordx4 v43, s[8:11], s52 offen offset:3072 lds
s_branch L_join
L_loader:
s_mov_b32 s8, s66
s_mov_b32 s9, s67
s_mov_b32 s10, 256000
s_mov_b32 s11, 0x20000
s_mov_b32 s12, s70
s_mov_b32 s13, s71
s_mov_b32 s14, 13107200
s_mov_b32 s15, 0x20000
s_mov_b32 s24, s80
s_mov_b32 s25, s81
s_mov_b32 s26, 256
s_mov_b32 s27, 0x20000
s_mov_b32 s4, s64
s_mov_b32 s5, s65
s_mov_b32 s6, 1638400
s_mov_b32 s7, 0x20000
s_mov_b32 s16, s82
s_mov_b32 s17, s83
s_mov_b32 s18, 819200
s_mov_b32 s19, 0x20000
s_add_u32 s20, s82, 2097152
s_addc_u32 s21, s83, 0
s_mov_b32 s22, 16777216
s_mov_b32 s23, 0x20000
s_add_u32 s32, s82, 1048576
s_addc_u32 s33, s83, 0
s_mov_b32 s34, 8192
s_mov_b32 s35, 0x20000
v_and_b32 v13, 31, v7
v_lshrrev_b32 v14, 2, v13
v_and_b32 v13, 3, v13
v_lshlrev_b32 v13, 4, v13
v_lshl_add_u32 v13, v14, 8, v13
v_lshrrev_b32 v15, 5, v7
v_lshl_add_u32 v13, v15, 7, v13
v_lshl_add_u32 v13, v6, 14, v13
v_and_b32 v14, 1, v14
v_lshl_add_u32 v1, v14, 6, v13
v_xor_b32 v2, 64, v1
v_xor_b32 v13, v44, v15
v_lshlrev_b32 v13, 4, v13
v_and_b32 v14, 31, v7
v_lshl_add_u32 v13, v14, 8, v13
v_lshl_add_u32 v32, v6, 14, v13
v_xor_b32 v33, 32, v32
v_xor_b32 v34, 64, v32
v_xor_b32 v35, 96, v32
v_xor_b32 v36, 128, v32
v_xor_b32 v37, 160, v32
v_xor_b32 v38, 192, v32
v_xor_b32 v39, 224, v32
v_xor_b32 v56, 0x10000, v32
v_xor_b32 v57, 0x10000, v33
v_xor_b32 v58, 0x10000, v34
v_xor_b32 v59, 0x10000, v35
v_xor_b32 v60, 0x10000, v36
v_xor_b32 v61, 0x10000, v37
v_xor_b32 v62, 0x10000, v38
v_xor_b32 v63, 0x10000, v39
v_and_b32 v13, 1, v7
v_bfe_u32 v14, v7, 4, 1
v_lshl_add_u32 v13, v13, 1, v14
v_mul_u32_u24 v13, 2112, v13
v_bfe_u32 v14, v7, 2, 2
v_lshl_add_u32 v14, v15, 3, v14
v_lshl_add_u32 v13, v14, 4, v13
v_bfe_u32 v14, v7, 1, 1
v_lshl_add_u32 v13, v14, 3, v13
v_add_u32 v3, 131072, v13
v_mov_b32 v15, v3
v_bfe_u32 v13, v7, 4, 1
v_bfe_u32 v14, v7, 3, 1
v_cmp_eq_u32 vcc, v13, v14
v_mov_b32 v13, 0x3f80
v_bfe_u32 v14, v7, 2, 1
v_cndmask_b32 v13, 0, v13, vcc
v_cmp_eq_u32 vcc, 0, v14
s_nop 1
v_cndmask_b32 v8, 0, v13, vcc
v_xor_b32 v9, v8, v13
v_mov_b32 v10, v8
v_mov_b32 v11, v9
v_and_b32 v13, 3, v7
v_mul_u32_u24 v12, 0x5555, v13
s_mov_b32 s53, 0x110000
s_mov_b32 s54, 0
s_lshl_b32 s55, s37, 2
s_add_u32 s55, s55, s3
s_mul_i32 s55, s55, 51200
s_mov_b32 s60, s2
s_mov_b32 s61, 0
v_mov_b32 v50, 0
v_mov_b32 v49, 0x7ff00000
v_cmp_gt_u32 vcc, 32, v7
s_lshr_b32 s44, s2, 3
s_lshl_b32 s44, s44, 13
s_and_b32 s52, s3, 1
s_lshl_b32 s52, s52, 12
s_add_u32 s44, s44, s52
v_cndmask_b32 v48, v49, v46, vcc
buffer_load_dword v47, v48, s[8:11], s44 offen
s_and_b32 s52, s36, 7
s_lshl_b32 s52, s52, 16
s_lshl_b32 s44, s36, 4
s_add_u32 s52, s52, s44
v_and_b32 v48, 31, v7
v_lshlrev_b32 v48, 10, v48
v_lshrrev_b32 v49, 5, v7
v_lshl_add_u32 v48, v49, 19, v48
s_and_b32 s44, s3, 1
s_lshl_b32 s44, s44, 15
s_add_u32 s52, s52, s44
s_add_u32 s52, s52, s45
v_lshlrev_b32 v49, 25, v49
v_add_u32 v48, v48, v49
buffer_load_dword v47, v48, s[12:15], s52 offen
s_sub_u32 s50, s50, 0x20000
s_sub_u32 s51, s51, 0x8000
s_sub_u32 s47, s47, 4224
s_mov_b32 s39, 2
v_subrev_u32 v4, 0x40000, v4
L_ld:
s_add_u32 m0, s51, 0
s_add_u32 s52, s50, 0
buffer_load_dwordx4 v40, s[8:11], s52 offen offset:0 lds
buffer_load_dwordx4 v41, s[8:11], s52 offen offset:1024 lds
s_add_u32 m0, s51, 0
s_add_u32 s52, s50, 0
buffer_load_dwordx4 v42, s[8:11], s52 offen offset:2048 lds
buffer_load_dwordx4 v43, s[8:11], s52 offen offset:3072 lds
s_add_u32 m0, s51, 4096
s_add_u32 s52, s50, 4096
buffer_load_dwordx4 v40, s[8:11], s52 offen offset:0 lds
buffer_load_dwordx4 v41, s[8:11], s52 offen offset:1024 lds
s_add_u32 m0, s51, 4096
s_add_u32 s52, s50, 4096
buffer_load_dwordx4 v42, s[8:11], s52 offen offset:2048 lds
buffer_load_dwordx4 v43, s[8:11], s52 offen offset:3072 lds
s_mov_b32 m0, s47
s_nop 0
buffer_load_dwordx4 v4, s[12:15], s45 offen lds
s_add_u32 m0, s47, 1024
s_add_u32 s44, s45, 65536
buffer_load_dwordx4 v4, s[12:15], s44 offen lds
s_add_u32 s50, s50, 0x20000
s_add_u32 s51, s51, 0x8000
s_add_u32 s47, s47, 4224
v_add_u32 v4, 0x40000, v4
s_sub_u32 s39, s39, 1
s_cmp_lg_u32 s39, 0
s_cbranch_scc1 L_ld
s_sub_u32 s50, s50, 0x20000
s_sub_u32 s51, s51, 0x8000
s_sub_u32 s47, s47, 4224
v_subrev_u32 v4, 0x40000, v4
s_and_b32 s52, s36, 7
s_lshl_b32 s52, s52, 16
s_lshl_b32 s44, s36, 4
s_add_u32 s52, s52, s44
v_and_b32 v48, 31, v7
v_lshlrev_b32 v48, 10, v48
v_lshrrev_b32 v49, 5, v7
v_lshl_add_u32 v48, v49, 19, v48
s_and_b32 s44, s3, 1
s_lshl_b32 s44, s44, 15
s_add_u32 s52, s52, s44
s_add_u32 s52, s52, s45
s_add_u32 s52, s52, 524288
v_lshlrev_b32 v49, 25, v49
v_add_u32 v48, v48, v49
buffer_load_dword v47, v48, s[12:15], s52 offen
buffer_load_dword v51, v50, s[24:27], 0 offen sc1
s_add_u32 m0, s51, 8192
s_add_u32 s52, s50, 8192
buffer_load_dwordx4 v40, s[8:11], s52 offen offset:0 lds
buffer_load_dwordx4 v41, s[8:11], s52 offen offset:1024 lds
s_add_u32 m0, s51, 8192
s_add_u32 s52, s50, 8192
buffer_load_dwordx4 v42, s[8:11], s52 offen offset:2048 lds
buffer_load_dwordx4 v43, s[8:11], s52 offen offset:3072 lds
s_add_u32 m0, s51, 12288
s_add_u32 s52, s50, 12288
buffer_load_dwordx4 v40, s[8:11], s52 offen offset:0 lds
buffer_load_dwordx4 v41, s[8:11], s52 offen offset:1024 lds
s_add_u32 m0, s51, 12288
s_add_u32 s52, s50, 12288
buffer_load_dwordx4 v42, s[8:11], s52 offen offset:2048 lds
buffer_load_dwordx4 v43, s[8:11], s52 offen offset:3072 lds
s_waitcnt vmcnt(10)
L_join:
s_add_u32 s47, s47, 8448
s_cmp_eq_u32 s47, s48
s_cselect_b32 s44, 25344, 0
s_sub_u32 s47, s47, s44
s_add_u32 s45, s45, 4*131072
s_cmp_eq_u32 s45, 100*131072
s_cselect_b32 s49, 0xff, s49
s_cmp_eq_u32 s45, s46
s_cselect_b32 s45, 96*131072, s45
s_barrier
ds_read_b64_tr_b16 v[96:97], v3 offset:0
ds_read_b64_tr_b16 v[98:99], v3 offset:64
ds_read_b128 a[0:3], v32 offset:0
ds_read_b64_tr_b16 v[100:101], v3 offset:256
ds_read_b64_tr_b16 v[102:103], v3 offset:320
ds_read_b128 a[4:7], v33 offset:0
ds_read_b64_tr_b16 v[104:105], v3 offset:512
ds_read_b64_tr_b16 v[106:107], v3 offset:576
ds_read_b128 a[8:11], v34 offset:0
ds_read_b64_tr_b16 v[108:109], v3 offset:768
ds_read_b64_tr_b16 v[110:111], v3 offset:832
ds_read_b128 a[12:15], v35 offset:0
ds_read_b64_tr_b16 v[112:113], v3 offset:1024
ds_read_b64_tr_b16 v[114:115], v3 offset:1088
ds_read_b128 a[16:19], v36 offset:0
ds_read_b64_tr_b16 v[116:117], v3 offset:1280
ds_read_b64_tr_b16 v[118:119], v3 offset:1344
ds_read_b128 a[20:23], v37 offset:0
ds_read_b64_tr_b16 v[120:121], v3 offset:1536
ds_read_b64_tr_b16 v[122:123], v3 offset:1600
ds_read_b128 a[24:27], v38 offset:0
ds_read_b64_tr_b16 v[124:125], v3 offset:1792
ds_read_b64_tr_b16 v[126:127], v3 offset:1856
ds_read_b128 a[28:31], v39 offset:0
s_add_u32 s54, s54, 8448
s_cmp_eq_u32 s54, 25344
s_cselect_b32 s54, 0, s54
v_add_u32 v3, s54, v15
s_waitcnt lgkmcnt(14)
v_mfma_f32_32x32x16_bf16 v[64:79], v[96:99], a[0:3], 0
s_add_u32 m0, s51, 65536
s_add_u32 s52, s50, 16384
buffer_load_dwordx4 v40, s[8:11], s52 offen offset:0 lds
buffer_load_dwordx4 v41, s[8:11], s52 offen offset:1024 lds
s_add_u32 m0, s51, 65536
s_add_u32 s52, s50, 16384
buffer_load_dwordx4 v42, s[8:11], s52 offen offset:2048 lds
buffer_load_dwordx4 v43, s[8:11], s52 offen offset:3072 lds
s_mov_b32 s28, s72
s_mov_b32 s29, s73
s_mov_b32 s30, 1024
s_mov_b32 s31, 0x20000
v_bfe_u32 v28, v7, 4, 1
v_lshlrev_b32 v28, 3, v28
s_lshl_b32 s44, s36, 4
s_lshl_b32 s43, s37, 20
s_add_u32 s44, s44, s43
buffer_load_dwordx2 v[30:31], v28, s[28:31], s44 offen
s_waitcnt lgkmcnt(14)
v_mfma_f32_32x32x16_bf16 v[64:79], v[100:103], a[4:7], v[64:79]
s_add_u32 m0, s51, 69632
s_add_u32 s52, s50, 20480
buffer_load_dwordx4 v40, s[8:11], s52 offen offset:0 lds
buffer_load_dwordx4 v41, s[8:11], s52 offen offset:1024 lds
s_add_u32 m0, s51, 69632
s_add_u32 s52, s50, 20480
buffer_load_dwordx4 v42, s[8:11], s52 offen offset:2048 lds
buffer_load_dwordx4 v43, s[8:11], s52 offen offset:3072 lds
s_cmp_ge_u32 s3, 2
s_cbranch_scc1 L_sig1
s_waitcnt vmcnt(17)
v_readfirstlane_b32 s56, v51
s_cmp_eq_u32 s56, 0
s_cbranch_scc1 L_fb_nona
L_nonda:
s_lshl_b32 s42, s41, 6
s_add_u32 s42, s42, s40
s_lshl_b32 s42, s42, 4
s_lshl_b32 s43, s3, 3
s_add_u32 s42, s42, s43
v_mov_b32 v48, s56
v_lshlrev_b32 v49, 20, v7
buffer_store_dword v48, v49, s[32:35], s42 offen sc1
L_sig1:
s_waitcnt lgkmcnt(14)
v_mfma_f32_32x32x16_bf16 v[64:79], v[104:107], a[8:11], v[64:79]
s_add_u32 m0, s51, 73728
s_add_u32 s52, s50, 24576
buffer_load_dwordx4 v40, s[8:11], s52 offen offset:0 lds
buffer_load_dwordx4 v41, s[8:11], s52 offen offset:1024 lds
s_add_u32 m0, s51, 73728
s_add_u32 s52, s50, 24576
buffer_load_dwordx4 v42, s[8:11], s52 offen offset:2048 lds
buffer_load_dwordx4 v43, s[8:11], s52 offen offset:3072 lds
s_waitcnt lgkmcnt(12)
v_mfma_f32_32x32x16_bf16 v[64:79], v[108:111], a[12:15], v[64:79]
s_add_u32 m0, s51, 77824
s_add_u32 s52, s50, 28672
buffer_load_dwordx4 v40, s[8:11], s52 offen offset:0 lds
buffer_load_dwordx4 v41, s[8:11], s52 offen offset:1024 lds
s_add_u32 m0, s51, 77824
s_add_u32 s52, s50, 28672
buffer_load_dwordx4 v42, s[8:11], s52 offen offset:2048 lds
buffer_load_dwordx4 v43, s[8:11], s52 offen offset:3072 lds
s_waitcnt lgkmcnt(9)
v_mfma_f32_32x32x16_bf16 v[64:79], v[112:115], a[16:19], v[64:79]
s_waitcnt vmcnt(17)
ds_read_b128 a[32:35], v32 offset:8192
ds_read_b128 a[36:39], v33 offset:8192
ds_read_b128 a[40:43], v34 offset:8192
ds_read_b128 a[44:47], v35 offset:8192
s_waitcnt lgkmcnt(10)
v_mfma_f32_32x32x16_bf16 v[64:79], v[116:119], a[20:23], v[64:79]
ds_read_b128 a[48:51], v36 offset:8192
ds_read_b128 a[52:55], v37 offset:8192
ds_read_b128 a[56:59], v38 offset:8192
ds_read_b128 a[60:63], v39 offset:8192
s_waitcnt lgkmcnt(11)
v_mfma_f32_32x32x16_bf16 v[64:79], v[120:123], a[24:27], v[64:79]
s_waitcnt lgkmcnt(8)
v_mfma_f32_32x32x16_bf16 v[64:79], v[124:127], a[28:31], v[64:79]
s_waitcnt lgkmcnt(0)
s_add_u32 m0, s51, 8192
s_add_u32 s52, s50, 32768
buffer_load_dwordx4 v40, s[8:11], s52 offen offset:0 lds
buffer_load_dwordx4 v41, s[8:11], s52 offen offset:1024 lds
s_add_u32 m0, s51, 8192
s_add_u32 s52, s50, 32768
buffer_load_dwordx4 v42, s[8:11], s52 offen offset:2048 lds
buffer_load_dwordx4 v43, s[8:11], s52 offen offset:3072 lds
v_mfma_f32_32x32x16_bf16 v[80:95], v[96:99], a[32:35], 0
s_add_u32 m0, s51, 12288
s_add_u32 s52, s50, 36864
buffer_load_dwordx4 v40, s[8:11], s52 offen offset:0 lds
buffer_load_dwordx4 v41, s[8:11], s52 offen offset:1024 lds
s_add_u32 m0, s51, 12288
s_add_u32 s52, s50, 36864
buffer_load_dwordx4 v42, s[8:11], s52 offen offset:2048 lds
buffer_load_dwordx4 v43, s[8:11], s52 offen offset:3072 lds
v_mfma_f32_32x32x16_bf16 v[80:95], v[100:103], a[36:39], v[80:95]
v_cvt_pk_bf16_f32 v64, v64, v65
v_cvt_pk_bf16_f32 v65, v66, v67
v_cvt_pk_bf16_f32 v66, v68, v69
v_cvt_pk_bf16_f32 v67, v70, v71
v_cvt_pk_bf16_f32 v72, v72, v73
v_mfma_f32_32x32x16_bf16 v[80:95], v[104:107], a[40:43], v[80:95]
v_cvt_pk_bf16_f32 v73, v74, v75
s_waitcnt vmcnt(16)
ds_read_b128 a[64:67], v56 offset:0
ds_read_b128 a[68:71], v57 offset:0
ds_read_b128 a[72:75], v58 offset:0
ds_read_b128 a[76:79], v59 offset:0
v_mfma_f32_32x32x16_bf16 v[80:95], v[108:111], a[44:47], v[80:95]
ds_read_b128 a[80:83], v60 offset:0
ds_read_b128 a[84:87], v61 offset:0
ds_read_b128 a[88:91], v62 offset:0
ds_read_b128 a[92:95], v63 offset:0
v_cvt_pk_bf16_f32 v74, v76, v77
v_cvt_pk_bf16_f32 v75, v78, v79
v_mfma_f32_32x32x16_bf16 v[80:95], v[112:115], a[48:51], v[80:95]
v_mfma_f32_32x32x16_bf16 v[80:95], v[116:119], a[52:55], v[80:95]
ds_write_b128 v1, v[64:67] offset:0
s_waitcnt lgkmcnt(1)
s_add_u32 m0, s51, 65536
s_add_u32 s52, s50, 40960
buffer_load_dwordx4 v40, s[8:11], s52 offen offset:0 lds
buffer_load_dwordx4 v41, s[8:11], s52 offen offset:1024 lds
s_add_u32 m0, s51, 65536
s_add_u32 s52, s50, 40960
buffer_load_dwordx4 v42, s[8:11], s52 offen offset:2048 lds
buffer_load_dwordx4 v43, s[8:11], s52 offen offset:3072 lds
v_mfma_f32_32x32x16_bf16 v[80:95], v[120:123], a[56:59], v[80:95]
s_waitcnt vmcnt(12)
ds_read_b128 a[96:99], v56 offset:8192
ds_read_b128 a[100:103], v57 offset:8192
ds_read_b128 a[104:107], v58 offset:8192
ds_read_b128 a[108:111], v59 offset:8192
s_add_u32 m0, s51, 69632
s_add_u32 s52, s50, 45056
buffer_load_dwordx4 v40, s[8:11], s52 offen offset:0 lds
buffer_load_dwordx4 v41, s[8:11], s52 offen offset:1024 lds
s_add_u32 m0, s51, 69632
s_add_u32 s52, s50, 45056
buffer_load_dwordx4 v42, s[8:11], s52 offen offset:2048 lds
buffer_load_dwordx4 v43, s[8:11], s52 offen offset:3072 lds
v_mfma_f32_32x32x16_bf16 v[80:95], v[124:127], a[60:63], v[80:95]
ds_write_b128 v2, v[72:75] offset:0
ds_read_b128 a[112:115], v60 offset:8192
ds_read_b128 a[116:119], v61 offset:8192
ds_read_b128 a[120:123], v62 offset:8192
ds_read_b128 a[124:127], v63 offset:8192
v_mfma_f32_32x32x16_bf16 v[64:79], v[96:99], a[64:67], 0
v_lshlrev_b32 v28, 16, v30
v_and_b32 v29, 0xffff0000, v30
v_lshlrev_b32 v30, 16, v31
v_and_b32 v31, 0xffff0000, v31
v_mov_b64 v[252:253], v[28:29]
v_mov_b64 v[254:255], v[30:31]
v_mfma_f32_32x32x16_bf16 v[64:79], v[100:103], a[68:71], v[64:79]
s_waitcnt lgkmcnt(0)
s_add_u32 m0, s51, 73728
s_add_u32 s52, s50, 49152
buffer_load_dwordx4 v40, s[8:11], s52 offen offset:0 lds
buffer_load_dwordx4 v41, s[8:11], s52 offen offset:1024 lds
s_add_u32 m0, s51, 73728
s_add_u32 s52, s50, 49152
buffer_load_dwordx4 v42, s[8:11], s52 offen offset:2048 lds
buffer_load_dwordx4 v43, s[8:11], s52 offen offset:3072 lds
v_mov_b64 v[248:249], v[28:29]
v_mov_b64 v[250:251], v[30:31]
v_cvt_pk_bf16_f32 v80, v80, v81
v_cvt_pk_bf16_f32 v81, v82, v83
v_cvt_pk_bf16_f32 v82, v84, v85
v_cvt_pk_bf16_f32 v83, v86, v87
v_cvt_pk_bf16_f32 v88, v88, v89
v_mfma_f32_32x32x16_bf16 v[64:79], v[104:107], a[72:75], v[64:79]
v_cvt_pk_bf16_f32 v89, v90, v91
s_add_u32 m0, s51, 77824
s_add_u32 s52, s50, 53248
buffer_load_dwordx4 v40, s[8:11], s52 offen offset:0 lds
buffer_load_dwordx4 v41, s[8:11], s52 offen offset:1024 lds
s_add_u32 m0, s51, 77824
s_add_u32 s52, s50, 53248
buffer_load_dwordx4 v42, s[8:11], s52 offen offset:2048 lds
buffer_load_dwordx4 v43, s[8:11], s52 offen offset:3072 lds
v_mov_b64 v[244:245], v[28:29]
v_mov_b64 v[246:247], v[30:31]
v_mfma_f32_32x32x16_bf16 v[64:79], v[108:111], a[76:79], v[64:79]
ds_write_b128 v1, v[80:83] offset:2048
v_mov_b64 v[240:241], v[28:29]
v_mov_b64 v[242:243], v[30:31]
v_cvt_pk_bf16_f32 v90, v92, v93
v_mfma_f32_32x32x16_bf16 v[64:79], v[112:115], a[80:83], v[64:79]
v_cvt_pk_bf16_f32 v91, v94, v95
s_waitcnt vmcnt(16)
ds_read_b128 a[128:131], v32 offset:8192
ds_read_b128 a[132:135], v33 offset:8192
ds_read_b128 a[136:139], v34 offset:8192
ds_read_b128 a[140:143], v35 offset:8192
s_cmp_eq_u32 s49, 0
s_cbranch_scc0 L_ws0_1
s_mov_b32 m0, s47
s_nop 0
buffer_load_dwordx4 v4, s[12:15], s45 offen lds
L_ws0_1:
v_mov_b64 v[236:237], v[28:29]
v_mov_b64 v[238:239], v[30:31]
v_mfma_f32_32x32x16_bf16 v[64:79], v[116:119], a[84:87], v[64:79]
ds_read_b128 a[144:147], v36 offset:8192
ds_read_b128 a[148:151], v37 offset:8192
ds_read_b128 a[152:155], v38 offset:8192
ds_read_b128 a[156:159], v39 offset:8192
v_readfirstlane_b32 s56, v51
s_cmp_eq_u32 s56, 0
s_cbranch_scc1 L_fb_nonb
L_nondb:
v_mov_b64 v[232:233], v[28:29]
v_mov_b64 v[234:235], v[30:31]
v_mfma_f32_32x32x16_bf16 v[64:79], v[120:123], a[88:91], v[64:79]
s_cmp_eq_u32 s49, 1
s_cbranch_scc0 L_ws1_2
s_mov_b32 m0, s47
s_nop 0
buffer_load_dwordx4 v4, s[12:15], s45 offen lds
L_ws1_2:
v_mov_b64 v[228:229], v[28:29]
v_mov_b64 v[230:231], v[30:31]
v_mfma_f32_32x32x16_bf16 v[64:79], v[124:127], a[92:95], v[64:79]
ds_write_b128 v2, v[88:91] offset:2048
v_mov_b64 v[224:225], v[28:29]
v_mov_b64 v[226:227], v[30:31]
v_mfma_f32_32x32x16_bf16 v[80:95], v[96:99], a[96:99], 0
s_cmp_eq_u32 s49, 2
s_cbranch_scc0 L_ws2_3
s_mov_b32 m0, s47
s_nop 0
buffer_load_dwordx4 v4, s[12:15], s45 offen lds
L_ws2_3:
v_mov_b64 v[220:221], v[28:29]
v_mov_b64 v[222:223], v[30:31]
v_mfma_f32_32x32x16_bf16 v[80:95], v[100:103], a[100:103], v[80:95]
s_cmp_lt_u32 s3, 2
s_cbranch_scc1 L_wsl
s_and_b32 s52, s3, 1
s_lshl_b32 s52, s52, 6
s_add_u32 s52, s52, s40
s_lshr_b32 s44, s52, 2
s_mov_b32 s43, 0
s_cmp_ge_u32 s44, 1
s_cselect_b32 s43, 1, s43
s_cmp_ge_u32 s44, 3
s_cselect_b32 s43, 2, s43
s_cmp_ge_u32 s44, 6
s_cselect_b32 s43, 3, s43
s_cmp_ge_u32 s44, 10
s_cselect_b32 s43, 4, s43
s_cmp_ge_u32 s44, 15
s_cselect_b32 s43, 5, s43
s_cmp_ge_u32 s44, 21
s_cselect_b32 s43, 6, s43
s_cmp_ge_u32 s44, 28
s_cselect_b32 s43, 7, s43
s_add_u32 s42, s43, 1
s_mul_i32 s42, s42, s43
s_lshr_b32 s42, s42, 1
s_sub_u32 s42, s44, s42
s_cmp_eq_u32 s42, s43
s_cselect_b32 s44, 0x100000, 0
s_lshl_b32 s42, s42, 2
s_and_b32 s57, s52, 3
s_add_u32 s42, s42, s57
v_bfe_u32 v32, v7, 2, 2
v_mul_u32_u24 v32, 25, v32
v_lshl_add_u32 v33, s43, 2, v45
v_add_u32 v32, v32, v33
v_and_b32 v34, 3, v7
v_mul_u32_u24 v34, 25, v34
v_add_u32 v34, s42, v34
v_max_u32 v33, s42, v33
v_cmp_gt_u32 vcc, 25, v33
v_mul_u32_u24 v33, 100, v34
v_add_lshl_u32 v33, v33, v32, 1
v_mul_u32_u24 v35, 100, v32
v_add_lshl_u32 v35, v35, v34, 1
v_mov_b32 v32, 0x7ff00000
v_cndmask_b32 v33, v32, v33, vcc
v_cndmask_b32 v35, v32, v35, vcc
s_mov_b32 s28, s68
s_mov_b32 s29, s69
s_mov_b32 s30, 20000
s_mov_b32 s31, 0x20000
buffer_load_ushort v36, v33, s[28:31], 0 offen
buffer_load_ushort v37, v35, s[28:31], s44 offen
s_mov_b32 s57, s52
L_wsl:
v_mov_b64 v[216:217], v[28:29]
v_mov_b64 v[218:219], v[30:31]
v_cvt_pk_bf16_f32 v64, v64, v65
v_cvt_pk_bf16_f32 v65, v66, v67
v_cvt_pk_bf16_f32 v66, v68, v69
v_cvt_pk_bf16_f32 v67, v70, v71
v_cvt_pk_bf16_f32 v72, v72, v73
v_mfma_f32_32x32x16_bf16 v[80:95], v[104:107], a[104:107], v[80:95]
v_cvt_pk_bf16_f32 v73, v74, v75
s_waitcnt vmcnt(8)
ds_read_b128 a[160:163], v56 offset:0
ds_read_b128 a[164:167], v57 offset:0
ds_read_b128 a[168:171], v58 offset:0
ds_read_b128 a[172:175], v59 offset:0
s_cmp_eq_u32 s49, 3
s_cbranch_scc0 L_ws3_4
s_mov_b32 m0, s47
s_nop 0
buffer_load_dwordx4 v4, s[12:15], s45 offen lds
L_ws3_4:
v_mov_b64 v[212:213], v[28:29]
v_mov_b64 v[214:215], v[30:31]
v_mfma_f32_32x32x16_bf16 v[80:95], v[108:111], a[108:111], v[80:95]
ds_write_b128 v1, v[64:67] offset:4096
ds_read_b128 a[176:179], v60 offset:0
ds_read_b128 a[180:183], v61 offset:0
ds_read_b128 a[184:187], v62 offset:0
ds_read_b128 a[188:191], v63 offset:0
v_mov_b64 v[208:209], v[28:29]
v_mov_b64 v[210:211], v[30:31]
v_cvt_pk_bf16_f32 v74, v76, v77
v_mfma_f32_32x32x16_bf16 v[80:95], v[112:115], a[112:115], v[80:95]
v_cvt_pk_bf16_f32 v75, v78, v79
v_mov_b64 v[204:205], v[28:29]
v_mov_b64 v[206:207], v[30:31]
v_mfma_f32_32x32x16_bf16 v[80:95], v[116:119], a[116:119], v[80:95]
s_waitcnt lgkmcnt(0)
s_add_u32 m0, s51, 65536
s_add_u32 s52, s50, 57344
buffer_load_dwordx4 v40, s[8:11], s52 offen offset:0 lds
buffer_load_dwordx4 v41, s[8:11], s52 offen offset:1024 lds
s_add_u32 m0, s51, 65536
s_add_u32 s52, s50, 57344
buffer_load_dwordx4 v42, s[8:11], s52 offen offset:2048 lds
buffer_load_dwordx4 v43, s[8:11], s52 offen offset:3072 lds
v_mov_b64 v[200:201], v[28:29]
v_mov_b64 v[202:203], v[30:31]
v_mfma_f32_32x32x16_bf16 v[80:95], v[120:123], a[120:123], v[80:95]
s_add_u32 m0, s51, 69632
s_add_u32 s52, s50, 61440
buffer_load_dwordx4 v40, s[8:11], s52 offen offset:0 lds
buffer_load_dwordx4 v41, s[8:11], s52 offen offset:1024 lds
s_add_u32 m0, s51, 69632
s_add_u32 s52, s50, 61440
buffer_load_dwordx4 v42, s[8:11], s52 offen offset:2048 lds
buffer_load_dwordx4 v43, s[8:11], s52 offen offset:3072 lds
v_mov_b64 v[196:197], v[28:29]
v_mov_b64 v[198:199], v[30:31]
v_mfma_f32_32x32x16_bf16 v[80:95], v[124:127], a[124:127], v[80:95]
ds_write_b128 v2, v[72:75] offset:4096
v_mov_b64 v[192:193], v[28:29]
v_mov_b64 v[194:195], v[30:31]
s_lshl_b32 s43, s37, 10
buffer_load_dwordx3 v[52:54], v5, s[32:35], s43 offen sc1
v_mfma_f32_32x32x16_bf16 v[64:79], v[96:99], a[128:131], 0
s_cmp_eq_u32 s49, 0
s_cbranch_scc0 L_ws4_5
s_add_u32 m0, s47, 1024
s_add_u32 s44, s45, 65536
buffer_load_dwordx4 v4, s[12:15], s44 offen lds
L_ws4_5:
s_and_b32 s39, s36, 7
s_lshl_b32 s39, s39, 16
s_lshl_b32 s44, s36, 4
s_add_u32 s39, s39, s44
s_lshl_b32 s44, s3, 14
s_add_u32 s39, s39, s44
v_and_b32 v0, 0x30, v7
v_lshlrev_b32 v0, 24, v0
v_lshl_add_u32 v0, v7, 10, v0
v_add_u32 v0, s39, v0
s_mul_i32 s39, s37, 24*131072
s_add_u32 s39, s39, 1048576
v_mov_b64 v[188:189], v[28:29]
v_mov_b64 v[190:191], v[30:31]
v_mfma_f32_32x32x16_bf16 v[64:79], v[100:103], a[132:135], v[64:79]
v_mov_b64 v[184:185], v[28:29]
v_mov_b64 v[186:187], v[30:31]
v_cvt_pk_bf16_f32 v80, v80, v81
v_cvt_pk_bf16_f32 v81, v82, v83
v_cvt_pk_bf16_f32 v82, v84, v85
v_cvt_pk_bf16_f32 v83, v86, v87
v_cvt_pk_bf16_f32 v88, v88, v89
v_mfma_f32_32x32x16_bf16 v[64:79], v[104:107], a[136:139], v[64:79]
v_cvt_pk_bf16_f32 v89, v90, v91
s_waitcnt vmcnt(9)
ds_read_b128 a[192:195], v56 offset:8192
ds_read_b128 a[196:199], v57 offset:8192
ds_read_b128 a[200:203], v58 offset:8192
ds_read_b128 a[204:207], v59 offset:8192
s_cmp_eq_u32 s49, 1
s_cbranch_scc0 L_ws5_6
s_add_u32 m0, s47, 1024
s_add_u32 s44, s45, 65536
buffer_load_dwordx4 v4, s[12:15], s44 offen lds
L_ws5_6:
v_mov_b64 v[180:181], v[28:29]
v_mov_b64 v[182:183], v[30:31]
v_mfma_f32_32x32x16_bf16 v[64:79], v[108:111], a[140:143], v[64:79]
ds_write_b128 v1, v[80:83] offset:6144
ds_read_b128 a[208:211], v60 offset:8192
ds_read_b128 a[212:215], v61 offset:8192
ds_read_b128 a[216:219], v62 offset:8192
ds_read_b128 a[220:223], v63 offset:8192
v_mov_b64 v[176:177], v[28:29]
v_mov_b64 v[178:179], v[30:31]
v_cvt_pk_bf16_f32 v90, v92, v93
s_cmp_lt_u32 s3, 2
s_cbranch_scc1 L_wss
s_add_u32 s28, s82, 1114112
s_addc_u32 s29, s83, 0
s_mov_b32 s30, 131072
s_mov_b32 s31, 0x20000
s_lshl_b32 s44, s41, 15
s_lshl_b32 s43, s57, 8
s_add_u32 s44, s44, s43
v_lshlrev_b32 v38, 2, v7
s_waitcnt vmcnt(9)
v_lshlrev_b32 v36, 16, v36
v_lshlrev_b32 v37, 16, v37
v_add_f32 v36, v36, v37
buffer_store_dword v36, v38, s[28:31], s44 offen sc1
L_wss:
v_mfma_f32_32x32x16_bf16 v[64:79], v[112:115], a[144:147], v[64:79]
v_cvt_pk_bf16_f32 v91, v94, v95
s_cmp_eq_u32 s49, 2
s_cbranch_scc0 L_ws6_7
s_add_u32 m0, s47, 1024
s_add_u32 s44, s45, 65536
buffer_load_dwordx4 v4, s[12:15], s44 offen lds
L_ws6_7:
v_mov_b64 v[172:173], v[28:29]
v_mov_b64 v[174:175], v[30:31]
v_mfma_f32_32x32x16_bf16 v[64:79], v[116:119], a[148:151], v[64:79]
v_mov_b64 v[168:169], v[28:29]
v_mov_b64 v[170:171], v[30:31]
v_mfma_f32_32x32x16_bf16 v[64:79], v[120:123], a[152:155], v[64:79]
s_cmp_eq_u32 s49, 3
s_cbranch_scc0 L_ws7_8
s_add_u32 m0, s47, 1024
s_add_u32 s44, s45, 65536
buffer_load_dwordx4 v4, s[12:15], s44 offen lds
L_ws7_8:
v_mov_b64 v[164:165], v[28:29]
v_mov_b64 v[166:167], v[30:31]
v_mfma_f32_32x32x16_bf16 v[64:79], v[124:127], a[156:159], v[64:79]
ds_write_b128 v2, v[88:91] offset:6144
v_mov_b64 v[160:161], v[28:29]
v_mov_b64 v[162:163], v[30:31]
v_mfma_f32_32x32x16_bf16 v[80:95], v[96:99], a[160:163], 0
v_mov_b64 v[156:157], v[28:29]
v_mov_b64 v[158:159], v[30:31]
v_mfma_f32_32x32x16_bf16 v[80:95], v[100:103], a[164:167], v[80:95]
v_mov_b64 v[152:153], v[28:29]
v_mov_b64 v[154:155], v[30:31]
v_cvt_pk_bf16_f32 v64, v64, v65
v_cvt_pk_bf16_f32 v65, v66, v67
v_cvt_pk_bf16_f32 v66, v68, v69
v_cvt_pk_bf16_f32 v67, v70, v71
v_cvt_pk_bf16_f32 v72, v72, v73
v_mfma_f32_32x32x16_bf16 v[80:95], v[104:107], a[168:171], v[80:95]
v_cvt_pk_bf16_f32 v73, v74, v75
v_mov_b64 v[148:149], v[28:29]
v_mov_b64 v[150:151], v[30:31]
v_mfma_f32_32x32x16_bf16 v[80:95], v[108:111], a[172:175], v[80:95]
ds_write_b128 v1, v[64:67] offset:8192
v_mov_b64 v[144:145], v[28:29]
v_mov_b64 v[146:147], v[30:31]
v_cvt_pk_bf16_f32 v74, v76, v77
s_waitcnt vmcnt(0)
s_mov_b32 s42, 40000
s_cmp_eq_u32 s3, 1
s_cselect_b32 s42, 400, s42
s_lshl_b32 s43, s37, 10
L_poll1:
v_xor_b32 v52, s56, v52
v_xor_b32 v54, s56, v54
v_or_b32 v52, v52, v54
v_cmp_eq_u32 vcc, 0, v52
s_nop 1
s_cmp_eq_u64 vcc, -1
s_cbranch_scc1 L_poll1d
s_sleep 8
buffer_load_dwordx3 v[52:54], v5, s[32:35], s43 offen sc1
s_waitcnt vmcnt(0)
s_sub_u32 s42, s42, 1
s_cmp_lg_u32 s42, 0
s_cbranch_scc1 L_poll1
s_cmp_eq_u32 s3, 1
s_cbranch_scc1 L_fb1
L_poll1d:
s_waitcnt vmcnt(0)
buffer_load_dwordx4 v[16:19], v5, s[16:19], s55 offen offset:0 sc1
buffer_load_dwordx4 v[20:23], v5, s[16:19], s55 offen offset:1024 sc1
buffer_load_dwordx4 v[24:27], v5, s[16:19], s55 offen offset:2048 sc1
v_mfma_f32_32x32x16_bf16 v[80:95], v[112:115], a[176:179], v[80:95]
v_cvt_pk_bf16_f32 v75, v78, v79
ds_read_b128 a[224:227], v56 offset:0
ds_read_b128 a[228:231], v57 offset:0
ds_read_b128 a[232:235], v58 offset:0
ds_read_b128 a[236:239], v59 offset:0
v_mov_b64 v[140:141], v[28:29]
v_mov_b64 v[142:143], v[30:31]
v_mfma_f32_32x32x16_bf16 v[80:95], v[116:119], a[180:183], v[80:95]
ds_read_b128 a[240:243], v60 offset:0
ds_read_b128 a[244:247], v61 offset:0
ds_read_b128 a[248:251], v62 offset:0
ds_read_b128 a[252:255], v63 offset:0
s_add_u32 s47, s47, 8448
s_cmp_eq_u32 s47, s48
s_cselect_b32 s44, 25344, 0
s_sub_u32 s47, s47, s44
s_add_u32 s45, s45, 4*131072
s_cmp_eq_u32 s45, 100*131072
s_cselect_b32 s49, 0xff, s49
s_cmp_eq_u32 s45, s46
s_cselect_b32 s45, 96*131072, s45
buffer_load_dword v6, v0, s[12:15], s39 offen
s_add_u32 s39, s39, 4*131072
s_cmp_eq_u32 s39, s46
s_cselect_b32 s39, 96*131072, s39
v_cmp_gt_u32 vcc, 14, v7
s_lshl_b32 s44, s2, 2
s_add_u32 s44, s44, s3
s_mul_i32 s44, s44, 1600
v_mov_b32 v49, 0x7ff00000
v_cndmask_b32 v48, v49, v46, vcc
buffer_load_dword v6, v48, s[4:7], s44 offen
v_mov_b64 v[136:137], v[28:29]
v_mov_b64 v[138:139], v[30:31]
v_mfma_f32_32x32x16_bf16 v[80:95], v[120:123], a[184:187], v[80:95]
v_mov_b64 v[132:133], v[28:29]
v_mov_b64 v[134:135], v[30:31]
v_mfma_f32_32x32x16_bf16 v[80:95], v[124:127], a[188:191], v[80:95]
ds_write_b128 v2, v[72:75] offset:8192
v_mov_b64 v[128:129], v[28:29]
v_mov_b64 v[130:131], v[30:31]
s_waitcnt lgkmcnt(14)
v_mfma_f32_32x32x16_bf16 v[64:79], v[96:99], a[192:195], 0
s_waitcnt lgkmcnt(14)
v_mfma_f32_32x32x16_bf16 v[64:79], v[100:103], a[196:199], v[64:79]
v_cvt_pk_bf16_f32 v80, v80, v81
v_cvt_pk_bf16_f32 v81, v82, v83
v_cvt_pk_bf16_f32 v82, v84, v85
v_cvt_pk_bf16_f32 v83, v86, v87
v_cvt_pk_bf16_f32 v88, v88, v89
s_waitcnt lgkmcnt(14)
v_mfma_f32_32x32x16_bf16 v[64:79], v[104:107], a[200:203], v[64:79]
v_cvt_pk_bf16_f32 v89, v90, v91
s_waitcnt lgkmcnt(14)
v_mfma_f32_32x32x16_bf16 v[64:79], v[108:111], a[204:207], v[64:79]
ds_write_b128 v1, v[80:83] offset:10240
v_cvt_pk_bf16_f32 v90, v92, v93
s_waitcnt lgkmcnt(14)
v_mfma_f32_32x32x16_bf16 v[64:79], v[112:115], a[208:211], v[64:79]
v_cvt_pk_bf16_f32 v91, v94, v95
s_waitcnt lgkmcnt(14)
v_mfma_f32_32x32x16_bf16 v[64:79], v[116:119], a[212:215], v[64:79]
s_waitcnt lgkmcnt(13)
v_mfma_f32_32x32x16_bf16 v[64:79], v[120:123], a[216:219], v[64:79]
s_waitcnt lgkmcnt(12)
v_mfma_f32_32x32x16_bf16 v[64:79], v[124:127], a[220:223], v[64:79]
ds_write_b128 v2, v[88:91] offset:10240
s_barrier
s_waitcnt lgkmcnt(10)
v_mfma_f32_32x32x16_bf16 v[80:95], v[96:99], a[224:227], 0
ds_read_b64_tr_b16 v[96:97], v3 offset:0
ds_read_b64_tr_b16 v[98:99], v3 offset:64
s_waitcnt lgkmcnt(11)
v_mfma_f32_32x32x16_bf16 v[80:95], v[100:103], a[228:231], v[80:95]
ds_read_b64_tr_b16 v[100:101], v3 offset:256
ds_read_b64_tr_b16 v[102:103], v3 offset:320
v_cvt_pk_bf16_f32 v64, v64, v65
v_cvt_pk_bf16_f32 v65, v66, v67
v_cvt_pk_bf16_f32 v66, v68, v69
v_cvt_pk_bf16_f32 v67, v70, v71
v_cvt_pk_bf16_f32 v72, v72, v73
s_waitcnt lgkmcnt(12)
v_mfma_f32_32x32x16_bf16 v[80:95], v[104:107], a[232:235], v[80:95]
ds_read_b64_tr_b16 v[104:105], v3 offset:512
ds_read_b64_tr_b16 v[106:107], v3 offset:576
v_cvt_pk_bf16_f32 v73, v74, v75
s_waitcnt lgkmcnt(13)
v_mfma_f32_32x32x16_bf16 v[80:95], v[108:111], a[236:239], v[80:95]
ds_write_b128 v1, v[64:67] offset:12288
ds_read_b64_tr_b16 v[108:109], v3 offset:768
ds_read_b64_tr_b16 v[110:111], v3 offset:832
v_cvt_pk_bf16_f32 v74, v76, v77
s_cmp_lt_u32 s3, 2
s_cbranch_scc1 L_wsg
s_lshl_b32 s42, s41, 6
s_add_u32 s42, s42, s40
s_lshl_b32 s42, s42, 4
s_and_b32 s43, s3, 1
s_lshl_b32 s43, s43, 3
s_add_u32 s42, s42, s43
v_mov_b32 v13, s56
v_lshlrev_b32 v14, 20, v7
buffer_store_dword v13, v14, s[32:35], s42 offen offset:4 sc1
L_wsg:
s_waitcnt lgkmcnt(14)
v_mfma_f32_32x32x16_bf16 v[80:95], v[112:115], a[240:243], v[80:95]
ds_read_b64_tr_b16 v[112:113], v3 offset:1024
ds_read_b64_tr_b16 v[114:115], v3 offset:1088
v_cvt_pk_bf16_f32 v75, v78, v79
s_waitcnt lgkmcnt(14)
v_mfma_f32_32x32x16_bf16 v[80:95], v[116:119], a[244:247], v[80:95]
ds_read_b64_tr_b16 v[116:117], v3 offset:1280
ds_read_b64_tr_b16 v[118:119], v3 offset:1344
v_mov_b64 v[32:33], 0
v_mov_b64 v[34:35], 0
v_mov_b64 v[36:37], 0
v_mov_b64 v[38:39], 0
v_mov_b64 v[40:41], 0
v_mov_b64 v[42:43], 0
v_mov_b64 v[44:45], 0
v_mov_b64 v[46:47], 0
v_mov_b64 v[48:49], 0
v_mov_b64 v[50:51], 0
v_mov_b64 v[52:53], 0
v_mov_b64 v[54:55], 0
v_mov_b64 v[56:57], 0
v_mov_b64 v[58:59], 0
v_mov_b64 v[60:61], 0
v_mov_b64 v[62:63], 0
v_mov_b32 v13, 0x100000
v_mov_b32 v14, 0x100000
s_waitcnt lgkmcnt(14)
v_mfma_f32_32x32x16_bf16 v[80:95], v[120:123], a[248:251], v[80:95]
ds_read_b64_tr_b16 v[120:121], v3 offset:1536
ds_read_b64_tr_b16 v[122:123], v3 offset:1600
s_waitcnt lgkmcnt(14)
v_mfma_f32_32x32x16_bf16 v[80:95], v[124:127], a[252:255], v[80:95]
ds_write_b128 v2, v[72:75] offset:12288
ds_read_b64_tr_b16 v[124:125], v3 offset:1792
ds_read_b64_tr_b16 v[126:127], v3 offset:1856
s_add_u32 s54, s54, 8448
s_cmp_eq_u32 s54, 25344
s_cselect_b32 s54, 0, s54
v_add_u32 v3, s54, v15
s_mov_b32 s38, 5
s_nop 7
.p2align 6
L_LOOP:
s_waitcnt lgkmcnt(14)
v_mfma_f32_32x32x16_bf16 v[64:79], v[96:99], a[0:3], 0
ds_read_b128 v[40:43], v13
ds_read_b128 v[44:47], v14
v_add_u32_sdwa v13, v30, s53 dst_sel:DWORD dst_unused:UNUSED_PAD src0_sel:WORD_0 src1_sel:DWORD
v_add_u32_sdwa v14, v30, s53 dst_sel:DWORD dst_unused:UNUSED_PAD src0_sel:WORD_1 src1_sel:DWORD
v_cvt_pk_bf16_f32 v80, v80, v81
s_waitcnt lgkmcnt(14)
v_mfma_f32_32x32x16_bf16 v[64:79], v[100:103], a[4:7], v[64:79]
v_cvt_pk_bf16_f32 v81, v82, v83
v_cvt_pk_bf16_f32 v82, v84, v85
v_cvt_pk_bf16_f32 v83, v86, v87
v_cvt_pk_bf16_f32 v88, v88, v89
s_waitcnt lgkmcnt(9)
v_smfmac_f32_16x16x64_bf16 v[232:235], v[8:11], v[48:55], v12
v_cvt_pk_bf16_f32 v89, v90, v91
s_waitcnt lgkmcnt(14)
v_mfma_f32_32x32x16_bf16 v[64:79], v[104:107], a[8:11], v[64:79]
ds_read_b128 v[48:51], v13
ds_read_b128 v[52:55], v14
v_add_u32_sdwa v13, v31, s53 dst_sel:DWORD dst_unused:UNUSED_PAD src0_sel:WORD_0 src1_sel:DWORD
v_add_u32_sdwa v14, v31, s53 dst_sel:DWORD dst_unused:UNUSED_PAD src0_sel:WORD_1 src1_sel:DWORD
v_cvt_pk_bf16_f32 v90, v92, v93
s_waitcnt lgkmcnt(14)
v_mfma_f32_32x32x16_bf16 v[64:79], v[108:111], a[12:15], v[64:79]
ds_write_b128 v1, v[80:83] offset:14336
buffer_load_dwordx4 v[28:31], v5, s[16:19], s55 offen offset:3072 sc1
s_add_u32 s55, s55, 4096
s_waitcnt lgkmcnt(11)
v_smfmac_f32_16x16x64_bf16 v[236:239], v[8:11], v[56:63], v12
v_cvt_pk_bf16_f32 v91, v94, v95
s_waitcnt lgkmcnt(14)
v_mfma_f32_32x32x16_bf16 v[64:79], v[112:115], a[16:19], v[64:79]
ds_read_b128 v[56:59], v13
ds_read_b128 v[60:63], v14
s_xor_b32 s53, s53, 0x10000
s_and_b32 s53, s53, 0x10000
s_waitcnt vmcnt(4)
v_add_u32_sdwa v13, v16, s53 dst_sel:DWORD dst_unused:UNUSED_PAD src0_sel:WORD_0 src1_sel:DWORD
v_add_u32_sdwa v14, v16, s53 dst_sel:DWORD dst_unused:UNUSED_PAD src0_sel:WORD_1 src1_sel:DWORD
s_waitcnt lgkmcnt(14)
v_mfma_f32_32x32x16_bf16 v[64:79], v[116:119], a[20:23], v[64:79]
ds_write_b128 v2, v[88:91] offset:14336
s_waitcnt lgkmcnt(13)
v_smfmac_f32_16x16x64_bf16 v[240:243], v[8:11], v[32:39], v12
s_waitcnt lgkmcnt(0)
s_barrier
v_mfma_f32_32x32x16_bf16 v[64:79], v[120:123], a[24:27], v[64:79]
ds_read_b128 v[32:35], v13
ds_read_b128 v[36:39], v14
v_add_u32_sdwa v13, v17, s53 dst_sel:DWORD dst_unused:UNUSED_PAD src0_sel:WORD_0 src1_sel:DWORD
v_add_u32_sdwa v14, v17, s53 dst_sel:DWORD dst_unused:UNUSED_PAD src0_sel:WORD_1 src1_sel:DWORD
v_mfma_f32_32x32x16_bf16 v[64:79], v[124:127], a[28:31], v[64:79]
v_smfmac_f32_16x16x64_bf16 v[244:247], v[8:11], v[40:47], v12
v_mfma_f32_32x32x16_bf16 v[80:95], v[96:99], a[32:35], 0
ds_read_b128 v[40:43], v13
ds_read_b128 v[44:47], v14
v_add_u32_sdwa v13, v18, s53 dst_sel:DWORD dst_unused:UNUSED_PAD src0_sel:WORD_0 src1_sel:DWORD
v_add_u32_sdwa v14, v18, s53 dst_sel:DWORD dst_unused:UNUSED_PAD src0_sel:WORD_1 src1_sel:DWORD
v_cvt_pk_bf16_f32 v64, v64, v65
v_mfma_f32_32x32x16_bf16 v[80:95], v[100:103], a[36:39], v[80:95]
s_cmp_eq_u32 s49, 0
s_cbranch_scc0 L_ws0_lp
s_mov_b32 m0, s47
s_nop 0
buffer_load_dwordx4 v4, s[12:15], s45 offen lds
L_ws0_lp:
v_cvt_pk_bf16_f32 v65, v66, v67
v_cvt_pk_bf16_f32 v66, v68, v69
v_cvt_pk_bf16_f32 v67, v70, v71
v_smfmac_f32_16x16x64_bf16 v[248:251], v[8:11], v[48:55], v12
v_cvt_pk_bf16_f32 v72, v72, v73
v_mfma_f32_32x32x16_bf16 v[80:95], v[104:107], a[40:43], v[80:95]
ds_read_b128 v[48:51], v13
ds_read_b128 v[52:55], v14
v_add_u32_sdwa v13, v19, s53 dst_sel:DWORD dst_unused:UNUSED_PAD src0_sel:WORD_0 src1_sel:DWORD
v_add_u32_sdwa v14, v19, s53 dst_sel:DWORD dst_unused:UNUSED_PAD src0_sel:WORD_1 src1_sel:DWORD
v_cvt_pk_bf16_f32 v73, v74, v75
v_mfma_f32_32x32x16_bf16 v[80:95], v[108:111], a[44:47], v[80:95]
buffer_load_dwordx4 v[16:19], v5, s[16:19], s55 offen offset:0 sc1
v_cvt_pk_bf16_f32 v74, v76, v77
v_cvt_pk_bf16_f32 v75, v78, v79
v_smfmac_f32_16x16x64_bf16 v[252:255], v[8:11], v[56:63], v12
s_barrier
v_xor_b32 v1, 0x10000, v1
v_xor_b32 v2, 0x10000, v2
v_mfma_f32_32x32x16_bf16 v[80:95], v[112:115], a[48:51], v[80:95]
ds_read_b128 v[56:59], v13
ds_read_b128 v[60:63], v14
s_waitcnt vmcnt(3)
v_add_u32_sdwa v13, v20, s53 dst_sel:DWORD dst_unused:UNUSED_PAD src0_sel:WORD_0 src1_sel:DWORD
v_add_u32_sdwa v14, v20, s53 dst_sel:DWORD dst_unused:UNUSED_PAD src0_sel:WORD_1 src1_sel:DWORD
v_mfma_f32_32x32x16_bf16 v[80:95], v[116:119], a[52:55], v[80:95]
ds_write_b128 v1, v[64:67] offset:0
s_cmp_eq_u32 s49, 1
s_cbranch_scc0 L_ws1_lp
s_mov_b32 m0, s47
s_nop 0
buffer_load_dwordx4 v4, s[12:15], s45 offen lds
L_ws1_lp:
s_waitcnt lgkmcnt(7)
v_smfmac_f32_16x16x64_bf16 v[128:131], v[8:11], v[32:39], v12
v_mfma_f32_32x32x16_bf16 v[80:95], v[120:123], a[56:59], v[80:95]
ds_read_b128 v[32:35], v13
ds_read_b128 v[36:39], v14
v_add_u32_sdwa v13, v21, s53 dst_sel:DWORD dst_unused:UNUSED_PAD src0_sel:WORD_0 src1_sel:DWORD
v_add_u32_sdwa v14, v21, s53 dst_sel:DWORD dst_unused:UNUSED_PAD src0_sel:WORD_1 src1_sel:DWORD
v_mfma_f32_32x32x16_bf16 v[80:95], v[124:127], a[60:63], v[80:95]
ds_write_b128 v2, v[72:75] offset:0
s_waitcnt lgkmcnt(8)
v_smfmac_f32_16x16x64_bf16 v[132:135], v[8:11], v[40:47], v12
v_mfma_f32_32x32x16_bf16 v[64:79], v[96:99], a[64:67], 0
ds_read_b128 v[40:43], v13
ds_read_b128 v[44:47], v14
v_add_u32_sdwa v13, v22, s53 dst_sel:DWORD dst_unused:UNUSED_PAD src0_sel:WORD_0 src1_sel:DWORD
v_add_u32_sdwa v14, v22, s53 dst_sel:DWORD dst_unused:UNUSED_PAD src0_sel:WORD_1 src1_sel:DWORD
v_cvt_pk_bf16_f32 v80, v80, v81
v_mfma_f32_32x32x16_bf16 v[64:79], v[100:103], a[68:71], v[64:79]
s_cmp_eq_u32 s49, 2
s_cbranch_scc0 L_ws2_lp
s_mov_b32 m0, s47
s_nop 0
buffer_load_dwordx4 v4, s[12:15], s45 offen lds
L_ws2_lp:
v_cvt_pk_bf16_f32 v81, v82, v83
v_cvt_pk_bf16_f32 v82, v84, v85
v_cvt_pk_bf16_f32 v83, v86, v87
s_waitcnt lgkmcnt(8)
v_smfmac_f32_16x16x64_bf16 v[136:139], v[8:11], v[48:55], v12
v_cvt_pk_bf16_f32 v88, v88, v89
v_mfma_f32_32x32x16_bf16 v[64:79], v[104:107], a[72:75], v[64:79]
ds_read_b128 v[48:51], v13
ds_read_b128 v[52:55], v14
v_add_u32_sdwa v13, v23, s53 dst_sel:DWORD dst_unused:UNUSED_PAD src0_sel:WORD_0 src1_sel:DWORD
v_add_u32_sdwa v14, v23, s53 dst_sel:DWORD dst_unused:UNUSED_PAD src0_sel:WORD_1 src1_sel:DWORD
v_cvt_pk_bf16_f32 v89, v90, v91
v_mfma_f32_32x32x16_bf16 v[64:79], v[108:111], a[76:79], v[64:79]
ds_write_b128 v1, v[80:83] offset:2048
buffer_load_dwordx4 v[20:23], v5, s[16:19], s55 offen offset:1024 sc1
s_waitcnt lgkmcnt(9)
v_smfmac_f32_16x16x64_bf16 v[140:143], v[8:11], v[56:63], v12
v_cvt_pk_bf16_f32 v90, v92, v93
v_mfma_f32_32x32x16_bf16 v[64:79], v[112:115], a[80:83], v[64:79]
ds_read_b128 v[56:59], v13
ds_read_b128 v[60:63], v14
s_waitcnt vmcnt(3)
v_add_u32_sdwa v13, v24, s53 dst_sel:DWORD dst_unused:UNUSED_PAD src0_sel:WORD_0 src1_sel:DWORD
v_add_u32_sdwa v14, v24, s53 dst_sel:DWORD dst_unused:UNUSED_PAD src0_sel:WORD_1 src1_sel:DWORD
v_cvt_pk_bf16_f32 v91, v94, v95
v_mfma_f32_32x32x16_bf16 v[64:79], v[116:119], a[84:87], v[64:79]
s_cmp_eq_u32 s49, 3
s_cbranch_scc0 L_ws3_lp
s_mov_b32 m0, s47
s_nop 0
buffer_load_dwordx4 v4, s[12:15], s45 offen lds
L_ws3_lp:
s_waitcnt lgkmcnt(8)
v_smfmac_f32_16x16x64_bf16 v[144:147], v[8:11], v[32:39], v12
v_mfma_f32_32x32x16_bf16 v[64:79], v[120:123], a[88:91], v[64:79]
ds_read_b128 v[32:35], v13
ds_read_b128 v[36:39], v14
v_add_u32_sdwa v13, v25, s53 dst_sel:DWORD dst_unused:UNUSED_PAD src0_sel:WORD_0 src1_sel:DWORD
v_add_u32_sdwa v14, v25, s53 dst_sel:DWORD dst_unused:UNUSED_PAD src0_sel:WORD_1 src1_sel:DWORD
v_mfma_f32_32x32x16_bf16 v[64:79], v[124:127], a[92:95], v[64:79]
ds_write_b128 v2, v[88:91] offset:2048
s_waitcnt lgkmcnt(8)
v_smfmac_f32_16x16x64_bf16 v[148:151], v[8:11], v[40:47], v12
v_mfma_f32_32x32x16_bf16 v[80:95], v[96:99], a[96:99], 0
ds_read_b128 v[40:43], v13
ds_read_b128 v[44:47], v14
v_add_u32_sdwa v13, v26, s53 dst_sel:DWORD dst_unused:UNUSED_PAD src0_sel:WORD_0 src1_sel:DWORD
v_add_u32_sdwa v14, v26, s53 dst_sel:DWORD dst_unused:UNUSED_PAD src0_sel:WORD_1 src1_sel:DWORD
v_cvt_pk_bf16_f32 v64, v64, v65
v_mfma_f32_32x32x16_bf16 v[80:95], v[100:103], a[100:103], v[80:95]
s_cmp_eq_u32 s49, 0
s_cbranch_scc0 L_ws4_lp
s_add_u32 m0, s47, 1024
s_add_u32 s44, s45, 65536
buffer_load_dwordx4 v4, s[12:15], s44 offen lds
L_ws4_lp:
v_cvt_pk_bf16_f32 v65, v66, v67
v_cvt_pk_bf16_f32 v66, v68, v69
v_cvt_pk_bf16_f32 v67, v70, v71
s_waitcnt lgkmcnt(8)
v_smfmac_f32_16x16x64_bf16 v[152:155], v[8:11], v[48:55], v12
v_cvt_pk_bf16_f32 v72, v72, v73
v_mfma_f32_32x32x16_bf16 v[80:95], v[104:107], a[104:107], v[80:95]
ds_read_b128 v[48:51], v13
ds_read_b128 v[52:55], v14
v_add_u32_sdwa v13, v27, s53 dst_sel:DWORD dst_unused:UNUSED_PAD src0_sel:WORD_0 src1_sel:DWORD
v_add_u32_sdwa v14, v27, s53 dst_sel:DWORD dst_unused:UNUSED_PAD src0_sel:WORD_1 src1_sel:DWORD
v_cvt_pk_bf16_f32 v73, v74, v75
v_mfma_f32_32x32x16_bf16 v[80:95], v[108:111], a[108:111], v[80:95]
ds_write_b128 v1, v[64:67] offset:4096
buffer_load_dwordx4 v[24:27], v5, s[16:19], s55 offen offset:2048 sc1
s_waitcnt lgkmcnt(8)
v_smfmac_f32_16x16x64_bf16 v[156:159], v[8:11], v[56:63], v12
v_cvt_pk_bf16_f32 v74, v76, v77
v_mfma_f32_32x32x16_bf16 v[80:95], v[112:115], a[112:115], v[80:95]
ds_read_b128 v[56:59], v13
ds_read_b128 v[60:63], v14
s_waitcnt vmcnt(3)
v_add_u32_sdwa v13, v28, s53 dst_sel:DWORD dst_unused:UNUSED_PAD src0_sel:WORD_0 src1_sel:DWORD
v_add_u32_sdwa v14, v28, s53 dst_sel:DWORD dst_unused:UNUSED_PAD src0_sel:WORD_1 src1_sel:DWORD
v_cvt_pk_bf16_f32 v75, v78, v79
v_mfma_f32_32x32x16_bf16 v[80:95], v[116:119], a[116:119], v[80:95]
s_cmp_eq_u32 s49, 1
s_cbranch_scc0 L_ws5_lp
s_add_u32 m0, s47, 1024
s_add_u32 s44, s45, 65536
buffer_load_dwordx4 v4, s[12:15], s44 offen lds
L_ws5_lp:
s_waitcnt lgkmcnt(8)
v_smfmac_f32_16x16x64_bf16 v[160:163], v[8:11], v[32:39], v12
v_mfma_f32_32x32x16_bf16 v[80:95], v[120:123], a[120:123], v[80:95]
ds_read_b128 v[32:35], v13
ds_read_b128 v[36:39], v14
v_add_u32_sdwa v13, v29, s53 dst_sel:DWORD dst_unused:UNUSED_PAD src0_sel:WORD_0 src1_sel:DWORD
v_add_u32_sdwa v14, v29, s53 dst_sel:DWORD dst_unused:UNUSED_PAD src0_sel:WORD_1 src1_sel:DWORD
v_mfma_f32_32x32x16_bf16 v[80:95], v[124:127], a[124:127], v[80:95]
ds_write_b128 v2, v[72:75] offset:4096
s_waitcnt lgkmcnt(8)
v_smfmac_f32_16x16x64_bf16 v[164:167], v[8:11], v[40:47], v12
v_mfma_f32_32x32x16_bf16 v[64:79], v[96:99], a[128:131], 0
ds_read_b128 v[40:43], v13
ds_read_b128 v[44:47], v14
v_add_u32_sdwa v13, v30, s53 dst_sel:DWORD dst_unused:UNUSED_PAD src0_sel:WORD_0 src1_sel:DWORD
v_add_u32_sdwa v14, v30, s53 dst_sel:DWORD dst_unused:UNUSED_PAD src0_sel:WORD_1 src1_sel:DWORD
v_cvt_pk_bf16_f32 v80, v80, v81
v_mfma_f32_32x32x16_bf16 v[64:79], v[100:103], a[132:135], v[64:79]
s_cmp_eq_u32 s49, 2
s_cbranch_scc0 L_ws6_lp
s_add_u32 m0, s47, 1024
s_add_u32 s44, s45, 65536
buffer_load_dwordx4 v4, s[12:15], s44 offen lds
L_ws6_lp:
v_cvt_pk_bf16_f32 v81, v82, v83
v_cvt_pk_bf16_f32 v82, v84, v85
v_cvt_pk_bf16_f32 v83, v86, v87
s_waitcnt lgkmcnt(8)
v_smfmac_f32_16x16x64_bf16 v[168:171], v[8:11], v[48:55], v12
v_cvt_pk_bf16_f32 v88, v88, v89
v_mfma_f32_32x32x16_bf16 v[64:79], v[104:107], a[136:139], v[64:79]
ds_read_b128 v[48:51], v13
ds_read_b128 v[52:55], v14
v_add_u32_sdwa v13, v31, s53 dst_sel:DWORD dst_unused:UNUSED_PAD src0_sel:WORD_0 src1_sel:DWORD
v_add_u32_sdwa v14, v31, s53 dst_sel:DWORD dst_unused:UNUSED_PAD src0_sel:WORD_1 src1_sel:DWORD
v_cvt_pk_bf16_f32 v89, v90, v91
v_mfma_f32_32x32x16_bf16 v[64:79], v[108:111], a[140:143], v[64:79]
ds_write_b128 v1, v[80:83] offset:6144
buffer_load_dwordx4 v[28:31], v5, s[16:19], s55 offen offset:3072 sc1
s_add_u32 s55, s55, 4096
s_waitcnt lgkmcnt(8)
v_smfmac_f32_16x16x64_bf16 v[172:175], v[8:11], v[56:63], v12
v_cvt_pk_bf16_f32 v90, v92, v93
v_mfma_f32_32x32x16_bf16 v[64:79], v[112:115], a[144:147], v[64:79]
ds_read_b128 v[56:59], v13
ds_read_b128 v[60:63], v14
s_waitcnt vmcnt(3)
v_add_u32_sdwa v13, v16, s53 dst_sel:DWORD dst_unused:UNUSED_PAD src0_sel:WORD_0 src1_sel:DWORD
v_add_u32_sdwa v14, v16, s53 dst_sel:DWORD dst_unused:UNUSED_PAD src0_sel:WORD_1 src1_sel:DWORD
v_cvt_pk_bf16_f32 v91, v94, v95
v_mfma_f32_32x32x16_bf16 v[64:79], v[116:119], a[148:151], v[64:79]
s_cmp_eq_u32 s49, 3
s_cbranch_scc0 L_ws7_lp
s_add_u32 m0, s47, 1024
s_add_u32 s44, s45, 65536
buffer_load_dwordx4 v4, s[12:15], s44 offen lds
L_ws7_lp:
s_waitcnt lgkmcnt(8)
v_smfmac_f32_16x16x64_bf16 v[176:179], v[8:11], v[32:39], v12
v_mfma_f32_32x32x16_bf16 v[64:79], v[120:123], a[152:155], v[64:79]
ds_read_b128 v[32:35], v13
ds_read_b128 v[36:39], v14
v_add_u32_sdwa v13, v17, s53 dst_sel:DWORD dst_unused:UNUSED_PAD src0_sel:WORD_0 src1_sel:DWORD
v_add_u32_sdwa v14, v17, s53 dst_sel:DWORD dst_unused:UNUSED_PAD src0_sel:WORD_1 src1_sel:DWORD
v_mfma_f32_32x32x16_bf16 v[64:79], v[124:127], a[156:159], v[64:79]
ds_write_b128 v2, v[88:91] offset:6144
s_add_u32 s47, s47, 8448
s_cmp_eq_u32 s47, s48
s_cselect_b32 s44, 25344, 0
s_sub_u32 s47, s47, s44
s_add_u32 s45, s45, 4*131072
s_cmp_eq_u32 s45, 100*131072
s_cselect_b32 s49, 0xff, s49
s_cmp_eq_u32 s45, s46
s_cselect_b32 s45, 96*131072, s45
s_waitcnt lgkmcnt(8)
v_smfmac_f32_16x16x64_bf16 v[180:183], v[8:11], v[40:47], v12
v_mfma_f32_32x32x16_bf16 v[80:95], v[96:99], a[160:163], 0
ds_read_b128 v[40:43], v13
ds_read_b128 v[44:47], v14
v_add_u32_sdwa v13, v18, s53 dst_sel:DWORD dst_unused:UNUSED_PAD src0_sel:WORD_0 src1_sel:DWORD
v_add_u32_sdwa v14, v18, s53 dst_sel:DWORD dst_unused:UNUSED_PAD src0_sel:WORD_1 src1_sel:DWORD
v_cvt_pk_bf16_f32 v64, v64, v65
v_mfma_f32_32x32x16_bf16 v[80:95], v[100:103], a[164:167], v[80:95]
v_cvt_pk_bf16_f32 v65, v66, v67
v_cvt_pk_bf16_f32 v66, v68, v69
v_cvt_pk_bf16_f32 v67, v70, v71
s_waitcnt lgkmcnt(8)
v_smfmac_f32_16x16x64_bf16 v[184:187], v[8:11], v[48:55], v12
v_cvt_pk_bf16_f32 v72, v72, v73
v_mfma_f32_32x32x16_bf16 v[80:95], v[104:107], a[168:171], v[80:95]
ds_read_b128 v[48:51], v13
ds_read_b128 v[52:55], v14
v_add_u32_sdwa v13, v19, s53 dst_sel:DWORD dst_unused:UNUSED_PAD src0_sel:WORD_0 src1_sel:DWORD
v_add_u32_sdwa v14, v19, s53 dst_sel:DWORD dst_unused:UNUSED_PAD src0_sel:WORD_1 src1_sel:DWORD
v_cvt_pk_bf16_f32 v73, v74, v75
v_mfma_f32_32x32x16_bf16 v[80:95], v[108:111], a[172:175], v[80:95]
ds_write_b128 v1, v[64:67] offset:8192
buffer_load_dwordx4 v[16:19], v5, s[16:19], s55 offen offset:0 sc1
s_waitcnt lgkmcnt(8)
v_smfmac_f32_16x16x64_bf16 v[188:191], v[8:11], v[56:63], v12
v_cvt_pk_bf16_f32 v74, v76, v77
v_mfma_f32_32x32x16_bf16 v[80:95], v[112:115], a[176:179], v[80:95]
ds_read_b128 v[56:59], v13
ds_read_b128 v[60:63], v14
s_waitcnt vmcnt(3)
v_add_u32_sdwa v13, v20, s53 dst_sel:DWORD dst_unused:UNUSED_PAD src0_sel:WORD_0 src1_sel:DWORD
v_add_u32_sdwa v14, v20, s53 dst_sel:DWORD dst_unused:UNUSED_PAD src0_sel:WORD_1 src1_sel:DWORD
v_cvt_pk_bf16_f32 v75, v78, v79
v_mfma_f32_32x32x16_bf16 v[80:95], v[116:119], a[180:183], v[80:95]
s_waitcnt lgkmcnt(8)
v_smfmac_f32_16x16x64_bf16 v[192:195], v[8:11], v[32:39], v12
v_mfma_f32_32x32x16_bf16 v[80:95], v[120:123], a[184:187], v[80:95]
ds_read_b128 v[32:35], v13
ds_read_b128 v[36:39], v14
v_add_u32_sdwa v13, v21, s53 dst_sel:DWORD dst_unused:UNUSED_PAD src0_sel:WORD_0 src1_sel:DWORD
v_add_u32_sdwa v14, v21, s53 dst_sel:DWORD dst_unused:UNUSED_PAD src0_sel:WORD_1 src1_sel:DWORD
v_mfma_f32_32x32x16_bf16 v[80:95], v[124:127], a[188:191], v[80:95]
ds_write_b128 v2, v[72:75] offset:8192
buffer_load_dword v6, v0, s[12:15], s39 offen
s_add_u32 s39, s39, 4*131072
s_cmp_eq_u32 s39, s46
s_cselect_b32 s39, 96*131072, s39
s_waitcnt lgkmcnt(8)
v_smfmac_f32_16x16x64_bf16 v[196:199], v[8:11], v[40:47], v12
v_mfma_f32_32x32x16_bf16 v[64:79], v[96:99], a[192:195], 0
ds_read_b128 v[40:43], v13
ds_read_b128 v[44:47], v14
v_add_u32_sdwa v13, v22, s53 dst_sel:DWORD dst_unused:UNUSED_PAD src0_sel:WORD_0 src1_sel:DWORD
v_add_u32_sdwa v14, v22, s53 dst_sel:DWORD dst_unused:UNUSED_PAD src0_sel:WORD_1 src1_sel:DWORD
v_cvt_pk_bf16_f32 v80, v80, v81
v_mfma_f32_32x32x16_bf16 v[64:79], v[100:103], a[196:199], v[64:79]
v_cvt_pk_bf16_f32 v81, v82, v83
v_cvt_pk_bf16_f32 v82, v84, v85
v_cvt_pk_bf16_f32 v83, v86, v87
s_waitcnt lgkmcnt(8)
v_smfmac_f32_16x16x64_bf16 v[200:203], v[8:11], v[48:55], v12
v_cvt_pk_bf16_f32 v88, v88, v89
v_mfma_f32_32x32x16_bf16 v[64:79], v[104:107], a[200:203], v[64:79]
ds_read_b128 v[48:51], v13
ds_read_b128 v[52:55], v14
v_add_u32_sdwa v13, v23, s53 dst_sel:DWORD dst_unused:UNUSED_PAD src0_sel:WORD_0 src1_sel:DWORD
v_add_u32_sdwa v14, v23, s53 dst_sel:DWORD dst_unused:UNUSED_PAD src0_sel:WORD_1 src1_sel:DWORD
v_cvt_pk_bf16_f32 v89, v90, v91
v_mfma_f32_32x32x16_bf16 v[64:79], v[108:111], a[204:207], v[64:79]
ds_write_b128 v1, v[80:83] offset:10240
buffer_load_dwordx4 v[20:23], v5, s[16:19], s55 offen offset:1024 sc1
s_waitcnt lgkmcnt(8)
v_smfmac_f32_16x16x64_bf16 v[204:207], v[8:11], v[56:63], v12
v_cvt_pk_bf16_f32 v90, v92, v93
v_mfma_f32_32x32x16_bf16 v[64:79], v[112:115], a[208:211], v[64:79]
ds_read_b128 v[56:59], v13
ds_read_b128 v[60:63], v14
s_waitcnt vmcnt(4)
v_add_u32_sdwa v13, v24, s53 dst_sel:DWORD dst_unused:UNUSED_PAD src0_sel:WORD_0 src1_sel:DWORD
v_add_u32_sdwa v14, v24, s53 dst_sel:DWORD dst_unused:UNUSED_PAD src0_sel:WORD_1 src1_sel:DWORD
v_cvt_pk_bf16_f32 v91, v94, v95
v_mfma_f32_32x32x16_bf16 v[64:79], v[116:119], a[212:215], v[64:79]
s_waitcnt lgkmcnt(8)
v_smfmac_f32_16x16x64_bf16 v[208:211], v[8:11], v[32:39], v12
s_waitcnt vmcnt(3)
s_barrier
v_mfma_f32_32x32x16_bf16 v[64:79], v[120:123], a[216:219], v[64:79]
ds_read_b128 v[32:35], v13
ds_read_b128 v[36:39], v14
v_add_u32_sdwa v13, v25, s53 dst_sel:DWORD dst_unused:UNUSED_PAD src0_sel:WORD_0 src1_sel:DWORD
v_add_u32_sdwa v14, v25, s53 dst_sel:DWORD dst_unused:UNUSED_PAD src0_sel:WORD_1 src1_sel:DWORD
v_mfma_f32_32x32x16_bf16 v[64:79], v[124:127], a[220:223], v[64:79]
ds_write_b128 v2, v[88:91] offset:10240
s_waitcnt lgkmcnt(8)
v_smfmac_f32_16x16x64_bf16 v[212:215], v[8:11], v[40:47], v12
v_mfma_f32_32x32x16_bf16 v[80:95], v[96:99], a[224:227], 0
ds_read_b128 v[40:43], v13
ds_read_b128 v[44:47], v14
ds_read_b64_tr_b16 v[96:97], v3 offset:0
ds_read_b64_tr_b16 v[98:99], v3 offset:64
v_add_u32_sdwa v13, v26, s53 dst_sel:DWORD dst_unused:UNUSED_PAD src0_sel:WORD_0 src1_sel:DWORD
v_add_u32_sdwa v14, v26, s53 dst_sel:DWORD dst_unused:UNUSED_PAD src0_sel:WORD_1 src1_sel:DWORD
v_cvt_pk_bf16_f32 v64, v64, v65
v_mfma_f32_32x32x16_bf16 v[80:95], v[100:103], a[228:231], v[80:95]
ds_read_b64_tr_b16 v[100:101], v3 offset:256
ds_read_b64_tr_b16 v[102:103], v3 offset:320
v_cvt_pk_bf16_f32 v65, v66, v67
v_cvt_pk_bf16_f32 v66, v68, v69
v_cvt_pk_bf16_f32 v67, v70, v71
s_waitcnt lgkmcnt(12)
v_smfmac_f32_16x16x64_bf16 v[216:219], v[8:11], v[48:55], v12
v_cvt_pk_bf16_f32 v72, v72, v73
v_mfma_f32_32x32x16_bf16 v[80:95], v[104:107], a[232:235], v[80:95]
ds_read_b128 v[48:51], v13
ds_read_b128 v[52:55], v14
ds_read_b64_tr_b16 v[104:105], v3 offset:512
ds_read_b64_tr_b16 v[106:107], v3 offset:576
v_add_u32_sdwa v13, v27, s53 dst_sel:DWORD dst_unused:UNUSED_PAD src0_sel:WORD_0 src1_sel:DWORD
v_add_u32_sdwa v14, v27, s53 dst_sel:DWORD dst_unused:UNUSED_PAD src0_sel:WORD_1 src1_sel:DWORD
v_cvt_pk_bf16_f32 v73, v74, v75
v_mfma_f32_32x32x16_bf16 v[80:95], v[108:111], a[236:239], v[80:95]
ds_write_b128 v1, v[64:67] offset:12288
ds_read_b64_tr_b16 v[108:109], v3 offset:768
ds_read_b64_tr_b16 v[110:111], v3 offset:832
buffer_load_dwordx4 v[24:27], v5, s[16:19], s55 offen offset:2048 sc1
s_waitcnt lgkmcnt(14)
v_smfmac_f32_16x16x64_bf16 v[220:223], v[8:11], v[56:63], v12
v_cvt_pk_bf16_f32 v74, v76, v77
v_mfma_f32_32x32x16_bf16 v[80:95], v[112:115], a[240:243], v[80:95]
ds_read_b128 v[56:59], v13
ds_read_b128 v[60:63], v14
ds_read_b64_tr_b16 v[112:113], v3 offset:1024
ds_read_b64_tr_b16 v[114:115], v3 offset:1088
v_add_u32_sdwa v13, v28, s53 dst_sel:DWORD dst_unused:UNUSED_PAD src0_sel:WORD_0 src1_sel:DWORD
v_add_u32_sdwa v14, v28, s53 dst_sel:DWORD dst_unused:UNUSED_PAD src0_sel:WORD_1 src1_sel:DWORD
v_cvt_pk_bf16_f32 v75, v78, v79
v_mfma_f32_32x32x16_bf16 v[80:95], v[116:119], a[244:247], v[80:95]
ds_read_b64_tr_b16 v[116:117], v3 offset:1280
ds_read_b64_tr_b16 v[118:119], v3 offset:1344
s_waitcnt lgkmcnt(14)
v_smfmac_f32_16x16x64_bf16 v[224:227], v[8:11], v[32:39], v12
v_mfma_f32_32x32x16_bf16 v[80:95], v[120:123], a[248:251], v[80:95]
ds_read_b128 v[32:35], v13
ds_read_b128 v[36:39], v14
ds_read_b64_tr_b16 v[120:121], v3 offset:1536
ds_read_b64_tr_b16 v[122:123], v3 offset:1600
v_add_u32_sdwa v13, v29, s53 dst_sel:DWORD dst_unused:UNUSED_PAD src0_sel:WORD_0 src1_sel:DWORD
v_add_u32_sdwa v14, v29, s53 dst_sel:DWORD dst_unused:UNUSED_PAD src0_sel:WORD_1 src1_sel:DWORD
v_mfma_f32_32x32x16_bf16 v[80:95], v[124:127], a[252:255], v[80:95]
ds_write_b128 v2, v[72:75] offset:12288
ds_read_b64_tr_b16 v[124:125], v3 offset:1792
ds_read_b64_tr_b16 v[126:127], v3 offset:1856
s_waitcnt lgkmcnt(14)
v_smfmac_f32_16x16x64_bf16 v[228:231], v[8:11], v[40:47], v12
s_add_u32 s54, s54, 8448
s_cmp_eq_u32 s54, 25344
s_cselect_b32 s54, 0, s54
v_add_u32 v3, s54, v15
s_sub_u32 s38, s38, 1
s_cmp_lg_u32 s38, 0
s_cbranch_scc1 L_LOOP
s_waitcnt lgkmcnt(14)
v_mfma_f32_32x32x16_bf16 v[64:79], v[96:99], a[0:3], 0
ds_read_b128 v[40:43], v13
ds_read_b128 v[44:47], v14
v_add_u32_sdwa v13, v30, s53 dst_sel:DWORD dst_unused:UNUSED_PAD src0_sel:WORD_0 src1_sel:DWORD
v_add_u32_sdwa v14, v30, s53 dst_sel:DWORD dst_unused:UNUSED_PAD src0_sel:WORD_1 src1_sel:DWORD
v_cvt_pk_bf16_f32 v80, v80, v81
s_waitcnt lgkmcnt(14)
v_mfma_f32_32x32x16_bf16 v[64:79], v[100:103], a[4:7], v[64:79]
s_lshl_b32 s43, s37, 10
buffer_load_dword v0, v5, s[32:35], s43 offen offset:4 sc1
buffer_load_dword v6, v5, s[32:35], s43 offen offset:12 sc1
v_cvt_pk_bf16_f32 v81, v82, v83
v_cvt_pk_bf16_f32 v82, v84, v85
v_cvt_pk_bf16_f32 v83, v86, v87
v_cvt_pk_bf16_f32 v88, v88, v89
s_waitcnt lgkmcnt(14)
v_smfmac_f32_16x16x64_bf16 v[232:235], v[8:11], v[48:55], v12
v_cvt_pk_bf16_f32 v89, v90, v91
s_waitcnt lgkmcnt(14)
v_mfma_f32_32x32x16_bf16 v[64:79], v[104:107], a[8:11], v[64:79]
ds_read_b128 v[48:51], v13
ds_read_b128 v[52:55], v14
v_add_u32_sdwa v13, v31, s53 dst_sel:DWORD dst_unused:UNUSED_PAD src0_sel:WORD_0 src1_sel:DWORD
v_add_u32_sdwa v14, v31, s53 dst_sel:DWORD dst_unused:UNUSED_PAD src0_sel:WORD_1 src1_sel:DWORD
v_cvt_pk_bf16_f32 v90, v92, v93
s_waitcnt lgkmcnt(14)
v_mfma_f32_32x32x16_bf16 v[64:79], v[108:111], a[12:15], v[64:79]
ds_write_b128 v1, v[80:83] offset:14336
buffer_load_dwordx4 v[28:31], v5, s[16:19], s55 offen offset:3072 sc1
s_add_u32 s55, s55, 4096
s_waitcnt lgkmcnt(14)
v_smfmac_f32_16x16x64_bf16 v[236:239], v[8:11], v[56:63], v12
v_cvt_pk_bf16_f32 v91, v94, v95
s_waitcnt lgkmcnt(14)
v_mfma_f32_32x32x16_bf16 v[64:79], v[112:115], a[16:19], v[64:79]
ds_read_b128 v[56:59], v13
ds_read_b128 v[60:63], v14
s_xor_b32 s53, s53, 0x10000
s_and_b32 s53, s53, 0x10000
s_waitcnt vmcnt(6)
v_add_u32_sdwa v13, v16, s53 dst_sel:DWORD dst_unused:UNUSED_PAD src0_sel:WORD_0 src1_sel:DWORD
v_add_u32_sdwa v14, v16, s53 dst_sel:DWORD dst_unused:UNUSED_PAD src0_sel:WORD_1 src1_sel:DWORD
s_waitcnt lgkmcnt(14)
v_mfma_f32_32x32x16_bf16 v[64:79], v[116:119], a[20:23], v[64:79]
ds_write_b128 v2, v[88:91] offset:14336
s_waitcnt lgkmcnt(13)
v_smfmac_f32_16x16x64_bf16 v[240:243], v[8:11], v[32:39], v12
s_waitcnt lgkmcnt(0)
s_barrier
v_mfma_f32_32x32x16_bf16 v[64:79], v[120:123], a[24:27], v[64:79]
ds_read_b128 v[32:35], v13
ds_read_b128 v[36:39], v14
v_add_u32_sdwa v13, v17, s53 dst_sel:DWORD dst_unused:UNUSED_PAD src0_sel:WORD_0 src1_sel:DWORD
v_add_u32_sdwa v14, v17, s53 dst_sel:DWORD dst_unused:UNUSED_PAD src0_sel:WORD_1 src1_sel:DWORD
v_mfma_f32_32x32x16_bf16 v[64:79], v[124:127], a[28:31], v[64:79]
v_smfmac_f32_16x16x64_bf16 v[244:247], v[8:11], v[40:47], v12
v_mfma_f32_32x32x16_bf16 v[80:95], v[96:99], a[32:35], 0
ds_read_b128 v[40:43], v13
ds_read_b128 v[44:47], v14
v_add_u32_sdwa v13, v18, s53 dst_sel:DWORD dst_unused:UNUSED_PAD src0_sel:WORD_0 src1_sel:DWORD
v_add_u32_sdwa v14, v18, s53 dst_sel:DWORD dst_unused:UNUSED_PAD src0_sel:WORD_1 src1_sel:DWORD
v_cvt_pk_bf16_f32 v64, v64, v65
v_mfma_f32_32x32x16_bf16 v[80:95], v[100:103], a[36:39], v[80:95]
v_cvt_pk_bf16_f32 v65, v66, v67
v_cvt_pk_bf16_f32 v66, v68, v69
v_cvt_pk_bf16_f32 v67, v70, v71
v_smfmac_f32_16x16x64_bf16 v[248:251], v[8:11], v[48:55], v12
v_cvt_pk_bf16_f32 v72, v72, v73
v_mfma_f32_32x32x16_bf16 v[80:95], v[104:107], a[40:43], v[80:95]
ds_read_b128 v[48:51], v13
ds_read_b128 v[52:55], v14
v_add_u32_sdwa v13, v19, s53 dst_sel:DWORD dst_unused:UNUSED_PAD src0_sel:WORD_0 src1_sel:DWORD
v_add_u32_sdwa v14, v19, s53 dst_sel:DWORD dst_unused:UNUSED_PAD src0_sel:WORD_1 src1_sel:DWORD
v_cvt_pk_bf16_f32 v73, v74, v75
v_mfma_f32_32x32x16_bf16 v[80:95], v[108:111], a[44:47], v[80:95]
buffer_load_dwordx4 v[16:19], v5, s[16:19], s55 offen offset:0 sc1
v_cvt_pk_bf16_f32 v74, v76, v77
v_cvt_pk_bf16_f32 v75, v78, v79
v_smfmac_f32_16x16x64_bf16 v[252:255], v[8:11], v[56:63], v12
s_barrier
v_xor_b32 v1, 0x10000, v1
v_xor_b32 v2, 0x10000, v2
v_mfma_f32_32x32x16_bf16 v[80:95], v[112:115], a[48:51], v[80:95]
ds_read_b128 v[56:59], v13
ds_read_b128 v[60:63], v14
s_waitcnt vmcnt(5)
v_add_u32_sdwa v13, v20, s53 dst_sel:DWORD dst_unused:UNUSED_PAD src0_sel:WORD_0 src1_sel:DWORD
v_add_u32_sdwa v14, v20, s53 dst_sel:DWORD dst_unused:UNUSED_PAD src0_sel:WORD_1 src1_sel:DWORD
s_waitcnt vmcnt(2)
s_mov_b32 s42, 40000
L_pollw:
v_xor_b32 v0, s56, v0
v_xor_b32 v6, s56, v6
v_or_b32 v0, v0, v6
v_cmp_eq_u32 vcc, 0, v0
s_nop 1
s_cmp_eq_u64 vcc, -1
s_cbranch_scc1 L_pollwd
s_sleep 4
buffer_load_dword v0, v5, s[32:35], s43 offen offset:4 sc1
buffer_load_dword v6, v5, s[32:35], s43 offen offset:12 sc1
s_waitcnt vmcnt(0)
s_sub_u32 s42, s42, 1
s_cmp_lg_u32 s42, 0
s_cbranch_scc1 L_pollw
L_pollwd:
v_mfma_f32_32x32x16_bf16 v[80:95], v[116:119], a[52:55], v[80:95]
ds_write_b128 v1, v[64:67] offset:0
v_and_b32 v4, 15, v7
v_lshlrev_b32 v4, 4, v4
v_bfe_u32 v0, v7, 4, 1
v_lshl_add_u32 v4, v0, 15, v4
v_lshrrev_b32 v0, 5, v7
v_lshl_add_u32 v4, v0, 9, v4
s_lshl_b32 s45, s37, 22
s_lshl_b32 s46, s36, 16
s_add_u32 s45, s45, s46
s_lshl_b32 s46, s3, 13
s_add_u32 s45, s45, s46
s_lshl_b32 s46, s37, 1
s_add_u32 s46, s46, 2
s_waitcnt lgkmcnt(7)
v_smfmac_f32_16x16x64_bf16 v[128:131], v[8:11], v[32:39], v12
v_mfma_f32_32x32x16_bf16 v[80:95], v[120:123], a[56:59], v[80:95]
ds_read_b128 v[32:35], v13
ds_read_b128 v[36:39], v14
v_add_u32_sdwa v13, v21, s53 dst_sel:DWORD dst_unused:UNUSED_PAD src0_sel:WORD_0 src1_sel:DWORD
v_add_u32_sdwa v14, v21, s53 dst_sel:DWORD dst_unused:UNUSED_PAD src0_sel:WORD_1 src1_sel:DWORD
v_mfma_f32_32x32x16_bf16 v[80:95], v[124:127], a[60:63], v[80:95]
ds_write_b128 v2, v[72:75] offset:0
s_add_u32 s28, s82, 1114112
s_addc_u32 s29, s83, 0
s_mov_b32 s30, 131072
s_mov_b32 s31, 0x20000
s_lshl_b32 s48, s37, 15
s_mul_i32 s44, s3, 7168
s_add_u32 s48, s48, s44
s_add_u32 s49, s44, 131072
s_add_u32 m0, s49, 0
s_add_u32 s50, s48, 0
buffer_load_dwordx4 v5, s[28:31], s50 offen offset:0 sc1 lds
s_waitcnt lgkmcnt(8)
v_smfmac_f32_16x16x64_bf16 v[132:135], v[8:11], v[40:47], v12
v_mfma_f32_32x32x16_bf16 v[64:79], v[96:99], a[64:67], 0
ds_read_b128 v[40:43], v13
ds_read_b128 v[44:47], v14
v_add_u32_sdwa v13, v22, s53 dst_sel:DWORD dst_unused:UNUSED_PAD src0_sel:WORD_0 src1_sel:DWORD
v_add_u32_sdwa v14, v22, s53 dst_sel:DWORD dst_unused:UNUSED_PAD src0_sel:WORD_1 src1_sel:DWORD
v_cvt_pk_bf16_f32 v80, v80, v81
v_mfma_f32_32x32x16_bf16 v[64:79], v[100:103], a[68:71], v[64:79]
buffer_load_dwordx4 v5, s[28:31], s50 offen offset:1024 sc1 lds
v_cvt_pk_bf16_f32 v81, v82, v83
v_cvt_pk_bf16_f32 v82, v84, v85
v_cvt_pk_bf16_f32 v83, v86, v87
s_waitcnt lgkmcnt(8)
v_smfmac_f32_16x16x64_bf16 v[136:139], v[8:11], v[48:55], v12
v_cvt_pk_bf16_f32 v88, v88, v89
v_lshrrev_b32 v15, 4, v7
v_mul_u32_u24 v15, 100, v15
s_lshl_b32 s59, s60, 4
s_lshl_b32 s44, s3, 2
s_add_u32 s59, s59, s44
s_mul_i32 s59, s59, 400
v_add_u32 v3, 131072, v5
v_mfma_f32_32x32x16_bf16 v[64:79], v[104:107], a[72:75], v[64:79]
ds_read_b128 v[48:51], v13
ds_read_b128 v[52:55], v14
v_add_u32_sdwa v13, v23, s53 dst_sel:DWORD dst_unused:UNUSED_PAD src0_sel:WORD_0 src1_sel:DWORD
v_add_u32_sdwa v14, v23, s53 dst_sel:DWORD dst_unused:UNUSED_PAD src0_sel:WORD_1 src1_sel:DWORD
v_cvt_pk_bf16_f32 v89, v90, v91
v_mfma_f32_32x32x16_bf16 v[64:79], v[108:111], a[76:79], v[64:79]
ds_write_b128 v1, v[80:83] offset:2048
buffer_load_dwordx4 v[20:23], v5, s[16:19], s55 offen offset:1024 sc1
buffer_load_dwordx4 v5, s[28:31], s50 offen offset:2048 sc1 lds
s_waitcnt lgkmcnt(9)
v_smfmac_f32_16x16x64_bf16 v[140:143], v[8:11], v[56:63], v12
v_cvt_pk_bf16_f32 v90, v92, v93
v_mfma_f32_32x32x16_bf16 v[64:79], v[112:115], a[80:83], v[64:79]
ds_read_b128 v[56:59], v13
ds_read_b128 v[60:63], v14
v_add_u32_sdwa v13, v24, s53 dst_sel:DWORD dst_unused:UNUSED_PAD src0_sel:WORD_0 src1_sel:DWORD
v_add_u32_sdwa v14, v24, s53 dst_sel:DWORD dst_unused:UNUSED_PAD src0_sel:WORD_1 src1_sel:DWORD
v_cvt_pk_bf16_f32 v91, v94, v95
v_mfma_f32_32x32x16_bf16 v[64:79], v[116:119], a[84:87], v[64:79]
buffer_load_dwordx4 v5, s[28:31], s50 offen offset:3072 sc1 lds
v_cvt_pk_bf16_f32 v128, v128, v129
v_cvt_pk_bf16_f32 v129, v130, v131
v_cvt_pk_bf16_f32 v130, v132, v133
s_waitcnt lgkmcnt(8)
v_smfmac_f32_16x16x64_bf16 v[144:147], v[8:11], v[32:39], v12
v_cvt_pk_bf16_f32 v131, v134, v135
v_mfma_f32_32x32x16_bf16 v[64:79], v[120:123], a[88:91], v[64:79]
ds_read_b128 v[32:35], v13
ds_read_b128 v[36:39], v14
v_add_u32_sdwa v13, v25, s53 dst_sel:DWORD dst_unused:UNUSED_PAD src0_sel:WORD_0 src1_sel:DWORD
v_add_u32_sdwa v14, v25, s53 dst_sel:DWORD dst_unused:UNUSED_PAD src0_sel:WORD_1 src1_sel:DWORD
v_cvt_pk_bf16_f32 v132, v136, v137
v_mfma_f32_32x32x16_bf16 v[64:79], v[124:127], a[92:95], v[64:79]
ds_write_b128 v2, v[88:91] offset:2048
s_add_u32 m0, s49, 4096
s_add_u32 s50, s48, 4096
buffer_load_dwordx4 v5, s[28:31], s50 offen offset:0 sc1 lds
s_waitcnt lgkmcnt(8)
v_smfmac_f32_16x16x64_bf16 v[148:151], v[8:11], v[40:47], v12
v_cvt_pk_bf16_f32 v133, v138, v139
v_mfma_f32_32x32x16_bf16 v[80:95], v[96:99], a[96:99], 0
ds_read_b128 v[40:43], v13
ds_read_b128 v[44:47], v14
v_add_u32_sdwa v13, v26, s53 dst_sel:DWORD dst_unused:UNUSED_PAD src0_sel:WORD_0 src1_sel:DWORD
v_add_u32_sdwa v14, v26, s53 dst_sel:DWORD dst_unused:UNUSED_PAD src0_sel:WORD_1 src1_sel:DWORD
v_cvt_pk_bf16_f32 v64, v64, v65
v_mfma_f32_32x32x16_bf16 v[80:95], v[100:103], a[100:103], v[80:95]
buffer_load_dwordx4 v5, s[28:31], s50 offen offset:1024 sc1 lds
v_cvt_pk_bf16_f32 v134, v140, v141
v_cvt_pk_bf16_f32 v135, v142, v143
s_add_u32 s47, s46, 0
s_and_b32 s47, s47, 7
s_lshl_b32 s47, s47, 10
s_add_u32 s47, s47, s45
buffer_store_dwordx4 v[128:131], v4, s[20:23], s47 offen offset:0 sc1
v_cvt_pk_bf16_f32 v65, v66, v67
v_cvt_pk_bf16_f32 v66, v68, v69
v_cvt_pk_bf16_f32 v67, v70, v71
s_waitcnt lgkmcnt(8)
v_smfmac_f32_16x16x64_bf16 v[152:155], v[8:11], v[48:55], v12
v_cvt_pk_bf16_f32 v72, v72, v73
v_mfma_f32_32x32x16_bf16 v[80:95], v[104:107], a[104:107], v[80:95]
ds_read_b128 v[48:51], v13
ds_read_b128 v[52:55], v14
v_add_u32_sdwa v13, v27, s53 dst_sel:DWORD dst_unused:UNUSED_PAD src0_sel:WORD_0 src1_sel:DWORD
v_add_u32_sdwa v14, v27, s53 dst_sel:DWORD dst_unused:UNUSED_PAD src0_sel:WORD_1 src1_sel:DWORD
v_cvt_pk_bf16_f32 v73, v74, v75
v_mfma_f32_32x32x16_bf16 v[80:95], v[108:111], a[108:111], v[80:95]
ds_write_b128 v1, v[64:67] offset:4096
buffer_load_dwordx4 v[24:27], v5, s[16:19], s55 offen offset:2048 sc1
buffer_load_dwordx4 v5, s[28:31], s50 offen offset:2048 sc1 lds
s_waitcnt lgkmcnt(8)
v_smfmac_f32_16x16x64_bf16 v[156:159], v[8:11], v[56:63], v12
v_cvt_pk_bf16_f32 v74, v76, v77
v_mfma_f32_32x32x16_bf16 v[80:95], v[112:115], a[112:115], v[80:95]
ds_read_b128 v[56:59], v13
ds_read_b128 v[60:63], v14
s_waitcnt vmcnt(11)
v_add_u32_sdwa v13, v28, s53 dst_sel:DWORD dst_unused:UNUSED_PAD src0_sel:WORD_0 src1_sel:DWORD
v_add_u32_sdwa v14, v28, s53 dst_sel:DWORD dst_unused:UNUSED_PAD src0_sel:WORD_1 src1_sel:DWORD
v_cvt_pk_bf16_f32 v75, v78, v79
v_mfma_f32_32x32x16_bf16 v[80:95], v[116:119], a[116:119], v[80:95]
buffer_store_dwordx4 v[132:135], v4, s[20:23], s47 offen offset:256 sc1
v_cvt_pk_bf16_f32 v144, v144, v145
v_cvt_pk_bf16_f32 v145, v146, v147
v_cvt_pk_bf16_f32 v146, v148, v149
s_waitcnt lgkmcnt(8)
v_smfmac_f32_16x16x64_bf16 v[160:163], v[8:11], v[32:39], v12
v_cvt_pk_bf16_f32 v147, v150, v151
v_mfma_f32_32x32x16_bf16 v[80:95], v[120:123], a[120:123], v[80:95]
ds_read_b128 v[32:35], v13
ds_read_b128 v[36:39], v14
v_add_u32_sdwa v13, v29, s53 dst_sel:DWORD dst_unused:UNUSED_PAD src0_sel:WORD_0 src1_sel:DWORD
v_add_u32_sdwa v14, v29, s53 dst_sel:DWORD dst_unused:UNUSED_PAD src0_sel:WORD_1 src1_sel:DWORD
v_cvt_pk_bf16_f32 v148, v152, v153
v_mfma_f32_32x32x16_bf16 v[80:95], v[124:127], a[124:127], v[80:95]
ds_write_b128 v2, v[72:75] offset:4096
s_waitcnt lgkmcnt(8)
v_smfmac_f32_16x16x64_bf16 v[164:167], v[8:11], v[40:47], v12
v_cvt_pk_bf16_f32 v149, v154, v155
v_mfma_f32_32x32x16_bf16 v[64:79], v[96:99], a[128:131], 0
ds_read_b128 v[40:43], v13
ds_read_b128 v[44:47], v14
v_add_u32_sdwa v13, v30, s53 dst_sel:DWORD dst_unused:UNUSED_PAD src0_sel:WORD_0 src1_sel:DWORD
v_add_u32_sdwa v14, v30, s53 dst_sel:DWORD dst_unused:UNUSED_PAD src0_sel:WORD_1 src1_sel:DWORD
v_cvt_pk_bf16_f32 v80, v80, v81
v_mfma_f32_32x32x16_bf16 v[64:79], v[100:103], a[132:135], v[64:79]
v_cvt_pk_bf16_f32 v150, v156, v157
v_cvt_pk_bf16_f32 v151, v158, v159
s_add_u32 s47, s46, 1
s_and_b32 s47, s47, 7
s_lshl_b32 s47, s47, 10
s_add_u32 s47, s47, s45
buffer_store_dwordx4 v[144:147], v4, s[20:23], s47 offen offset:0 sc1
v_cvt_pk_bf16_f32 v81, v82, v83
v_cvt_pk_bf16_f32 v82, v84, v85
v_cvt_pk_bf16_f32 v83, v86, v87
s_waitcnt lgkmcnt(8)
v_smfmac_f32_16x16x64_bf16 v[168:171], v[8:11], v[48:55], v12
v_cvt_pk_bf16_f32 v88, v88, v89
v_mfma_f32_32x32x16_bf16 v[64:79], v[104:107], a[136:139], v[64:79]
ds_read_b128 v[48:51], v13
ds_read_b128 v[52:55], v14
v_add_u32_sdwa v13, v31, s53 dst_sel:DWORD dst_unused:UNUSED_PAD src0_sel:WORD_0 src1_sel:DWORD
v_add_u32_sdwa v14, v31, s53 dst_sel:DWORD dst_unused:UNUSED_PAD src0_sel:WORD_1 src1_sel:DWORD
v_cvt_pk_bf16_f32 v89, v90, v91
v_mfma_f32_32x32x16_bf16 v[64:79], v[108:111], a[140:143], v[64:79]
ds_write_b128 v1, v[80:83] offset:6144
buffer_load_dwordx4 v[28:31], v5, s[16:19], s55 offen offset:3072 sc1
s_add_u32 s55, s55, 4096
s_waitcnt lgkmcnt(8)
v_smfmac_f32_16x16x64_bf16 v[172:175], v[8:11], v[56:63], v12
v_cvt_pk_bf16_f32 v90, v92, v93
v_and_b32 v140, 15, v7
v_lshrrev_b32 v141, 4, v7
s_add_u32 s57, s51, 65536
s_sub_u32 s8, s66, 3072
s_subb_u32 s9, s67, 0
s_mov_b32 s10, 259072
s_mov_b32 s11, 0x20000
v_xor_b32 v128, v141, v140
v_lshlrev_b32 v128, 4, v128
v_lshl_add_u32 v136, v140, 8, v128
v_add_u32 v136, s51, v136
v_mfma_f32_32x32x16_bf16 v[64:79], v[112:115], a[144:147], v[64:79]
ds_read_b128 v[56:59], v13
ds_read_b128 v[60:63], v14
s_waitcnt vmcnt(13)
v_add_u32_sdwa v13, v16, s53 dst_sel:DWORD dst_unused:UNUSED_PAD src0_sel:WORD_0 src1_sel:DWORD
v_add_u32_sdwa v14, v16, s53 dst_sel:DWORD dst_unused:UNUSED_PAD src0_sel:WORD_1 src1_sel:DWORD
v_cvt_pk_bf16_f32 v91, v94, v95
v_mfma_f32_32x32x16_bf16 v[64:79], v[116:119], a[148:151], v[64:79]
buffer_store_dwordx4 v[148:151], v4, s[20:23], s47 offen offset:256 sc1
v_cvt_pk_bf16_f32 v160, v160, v161
v_cvt_pk_bf16_f32 v161, v162, v163
v_cvt_pk_bf16_f32 v162, v164, v165
s_waitcnt lgkmcnt(8)
v_smfmac_f32_16x16x64_bf16 v[176:179], v[8:11], v[32:39], v12
v_cvt_pk_bf16_f32 v163, v166, v167
v_mfma_f32_32x32x16_bf16 v[64:79], v[120:123], a[152:155], v[64:79]
ds_read_b128 v[32:35], v13
ds_read_b128 v[36:39], v14
v_add_u32_sdwa v13, v17, s53 dst_sel:DWORD dst_unused:UNUSED_PAD src0_sel:WORD_0 src1_sel:DWORD
v_add_u32_sdwa v14, v17, s53 dst_sel:DWORD dst_unused:UNUSED_PAD src0_sel:WORD_1 src1_sel:DWORD
v_cvt_pk_bf16_f32 v164, v168, v169
v_mfma_f32_32x32x16_bf16 v[64:79], v[124:127], a[156:159], v[64:79]
ds_write_b128 v2, v[88:91] offset:6144
s_waitcnt lgkmcnt(8)
v_smfmac_f32_16x16x64_bf16 v[180:183], v[8:11], v[40:47], v12
v_cvt_pk_bf16_f32 v165, v170, v171
v_xor_b32 v131, 192, v128
v_xor_b32 v130, 128, v128
v_add_u32 v130, 1024, v130
v_xor_b32 v129, 64, v128
v_add_u32 v129, 2048, v129
v_xor_b32 v128, 0, v128
v_add_u32 v128, 3072, v128
v_mfma_f32_32x32x16_bf16 v[80:95], v[96:99], a[160:163], 0
ds_read_b128 v[40:43], v13
ds_read_b128 v[44:47], v14
v_add_u32_sdwa v13, v18, s53 dst_sel:DWORD dst_unused:UNUSED_PAD src0_sel:WORD_0 src1_sel:DWORD
v_add_u32_sdwa v14, v18, s53 dst_sel:DWORD dst_unused:UNUSED_PAD src0_sel:WORD_1 src1_sel:DWORD
v_cvt_pk_bf16_f32 v64, v64, v65
v_mfma_f32_32x32x16_bf16 v[80:95], v[100:103], a[164:167], v[80:95]
v_cvt_pk_bf16_f32 v166, v172, v173
v_cvt_pk_bf16_f32 v167, v174, v175
s_add_u32 s47, s46, 2
s_and_b32 s47, s47, 7
s_lshl_b32 s47, s47, 10
s_add_u32 s47, s47, s45
buffer_store_dwordx4 v[160:163], v4, s[20:23], s47 offen offset:0 sc1
v_cvt_pk_bf16_f32 v65, v66, v67
v_cvt_pk_bf16_f32 v66, v68, v69
v_cvt_pk_bf16_f32 v67, v70, v71
s_waitcnt lgkmcnt(8)
v_smfmac_f32_16x16x64_bf16 v[184:187], v[8:11], v[48:55], v12
v_cvt_pk_bf16_f32 v72, v72, v73
v_mfma_f32_32x32x16_bf16 v[80:95], v[104:107], a[168:171], v[80:95]
ds_read_b128 v[48:51], v13
ds_read_b128 v[52:55], v14
v_add_u32_sdwa v13, v19, s53 dst_sel:DWORD dst_unused:UNUSED_PAD src0_sel:WORD_0 src1_sel:DWORD
v_add_u32_sdwa v14, v19, s53 dst_sel:DWORD dst_unused:UNUSED_PAD src0_sel:WORD_1 src1_sel:DWORD
v_cvt_pk_bf16_f32 v73, v74, v75
v_mfma_f32_32x32x16_bf16 v[80:95], v[108:111], a[172:175], v[80:95]
ds_write_b128 v1, v[64:67] offset:8192
buffer_load_dwordx4 v[16:19], v5, s[16:19], s55 offen offset:0 sc1
s_waitcnt lgkmcnt(8)
v_smfmac_f32_16x16x64_bf16 v[188:191], v[8:11], v[56:63], v12
v_cvt_pk_bf16_f32 v74, v76, v77
v_xor_b32 v137, 64, v136
v_xor_b32 v138, 128, v136
v_xor_b32 v139, 192, v136
v_xor_b32 v132, 0x10000, v136
v_xor_b32 v133, 0x10000, v137
v_xor_b32 v134, 0x10000, v138
v_xor_b32 v135, 0x10000, v139
v_mfma_f32_32x32x16_bf16 v[80:95], v[112:115], a[176:179], v[80:95]
ds_read_b128 v[56:59], v13
ds_read_b128 v[60:63], v14
s_waitcnt vmcnt(13)
v_add_u32_sdwa v13, v20, s53 dst_sel:DWORD dst_unused:UNUSED_PAD src0_sel:WORD_0 src1_sel:DWORD
v_add_u32_sdwa v14, v20, s53 dst_sel:DWORD dst_unused:UNUSED_PAD src0_sel:WORD_1 src1_sel:DWORD
v_cvt_pk_bf16_f32 v75, v78, v79
v_mfma_f32_32x32x16_bf16 v[80:95], v[116:119], a[180:183], v[80:95]
buffer_store_dwordx4 v[164:167], v4, s[20:23], s47 offen offset:256 sc1
v_cvt_pk_bf16_f32 v176, v176, v177
v_cvt_pk_bf16_f32 v177, v178, v179
v_cvt_pk_bf16_f32 v178, v180, v181
s_waitcnt lgkmcnt(8)
v_smfmac_f32_16x16x64_bf16 v[192:195], v[8:11], v[32:39], v12
v_cvt_pk_bf16_f32 v179, v182, v183
v_mfma_f32_32x32x16_bf16 v[80:95], v[120:123], a[184:187], v[80:95]
ds_read_b128 v[32:35], v13
ds_read_b128 v[36:39], v14
v_add_u32_sdwa v13, v21, s53 dst_sel:DWORD dst_unused:UNUSED_PAD src0_sel:WORD_0 src1_sel:DWORD
v_add_u32_sdwa v14, v21, s53 dst_sel:DWORD dst_unused:UNUSED_PAD src0_sel:WORD_1 src1_sel:DWORD
v_cvt_pk_bf16_f32 v180, v184, v185
v_mfma_f32_32x32x16_bf16 v[80:95], v[124:127], a[188:191], v[80:95]
ds_write_b128 v2, v[72:75] offset:8192
buffer_load_dwordx4 v[160:163], v15, s[4:7], s59 offen offset:0
s_waitcnt lgkmcnt(8)
v_smfmac_f32_16x16x64_bf16 v[196:199], v[8:11], v[40:47], v12
v_cvt_pk_bf16_f32 v181, v186, v187
v_cmp_gt_u32 vcc, 4, v140
v_mov_b32 v143, 0x100000
s_nop 0
v_cndmask_b32 v140, v143, v132, vcc
v_cndmask_b32 v141, v143, v133, vcc
v_cndmask_b32 v142, v143, v134, vcc
v_cndmask_b32 v143, v143, v135, vcc
v_mfma_f32_32x32x16_bf16 v[64:79], v[96:99], a[192:195], 0
ds_read_b128 v[40:43], v13
ds_read_b128 v[44:47], v14
v_add_u32_sdwa v13, v22, s53 dst_sel:DWORD dst_unused:UNUSED_PAD src0_sel:WORD_0 src1_sel:DWORD
v_add_u32_sdwa v14, v22, s53 dst_sel:DWORD dst_unused:UNUSED_PAD src0_sel:WORD_1 src1_sel:DWORD
v_cvt_pk_bf16_f32 v80, v80, v81
v_mfma_f32_32x32x16_bf16 v[64:79], v[100:103], a[196:199], v[64:79]
v_cvt_pk_bf16_f32 v182, v188, v189
v_cvt_pk_bf16_f32 v183, v190, v191
s_add_u32 s47, s46, 3
s_and_b32 s47, s47, 7
s_lshl_b32 s47, s47, 10
s_add_u32 s47, s47, s45
buffer_store_dwordx4 v[176:179], v4, s[20:23], s47 offen offset:0 sc1
buffer_load_dwordx4 v[164:167], v15, s[4:7], s59 offen offset:16
v_cvt_pk_bf16_f32 v81, v82, v83
v_cvt_pk_bf16_f32 v82, v84, v85
v_cvt_pk_bf16_f32 v83, v86, v87
s_waitcnt lgkmcnt(8)
v_smfmac_f32_16x16x64_bf16 v[200:203], v[8:11], v[48:55], v12
v_cvt_pk_bf16_f32 v88, v88, v89
v_mfma_f32_32x32x16_bf16 v[64:79], v[104:107], a[200:203], v[64:79]
ds_read_b128 v[48:51], v13
ds_read_b128 v[52:55], v14
v_add_u32_sdwa v13, v23, s53 dst_sel:DWORD dst_unused:UNUSED_PAD src0_sel:WORD_0 src1_sel:DWORD
v_add_u32_sdwa v14, v23, s53 dst_sel:DWORD dst_unused:UNUSED_PAD src0_sel:WORD_1 src1_sel:DWORD
v_cvt_pk_bf16_f32 v89, v90, v91
v_mfma_f32_32x32x16_bf16 v[64:79], v[108:111], a[204:207], v[64:79]
ds_write_b128 v1, v[80:83] offset:10240
buffer_load_dwordx4 v[20:23], v5, s[16:19], s55 offen offset:1024 sc1
buffer_load_dwordx4 v[168:171], v15, s[4:7], s59 offen offset:32
s_waitcnt lgkmcnt(8)
v_smfmac_f32_16x16x64_bf16 v[204:207], v[8:11], v[56:63], v12
v_cvt_pk_bf16_f32 v90, v92, v93
v_mfma_f32_32x32x16_bf16 v[64:79], v[112:115], a[208:211], v[64:79]
ds_read_b128 v[56:59], v13
ds_read_b128 v[60:63], v14
s_waitcnt vmcnt(13)
v_add_u32_sdwa v13, v24, s53 dst_sel:DWORD dst_unused:UNUSED_PAD src0_sel:WORD_0 src1_sel:DWORD
v_add_u32_sdwa v14, v24, s53 dst_sel:DWORD dst_unused:UNUSED_PAD src0_sel:WORD_1 src1_sel:DWORD
v_cvt_pk_bf16_f32 v91, v94, v95
v_mfma_f32_32x32x16_bf16 v[64:79], v[116:119], a[212:215], v[64:79]
buffer_store_dwordx4 v[180:183], v4, s[20:23], s47 offen offset:256 sc1
v_cvt_pk_bf16_f32 v192, v192, v193
v_cvt_pk_bf16_f32 v193, v194, v195
v_cvt_pk_bf16_f32 v194, v196, v197
buffer_load_dwordx4 v[172:175], v15, s[4:7], s59 offen offset:48
s_waitcnt lgkmcnt(8)
v_smfmac_f32_16x16x64_bf16 v[208:211], v[8:11], v[32:39], v12
v_cvt_pk_bf16_f32 v195, v198, v199
v_mfma_f32_32x32x16_bf16 v[64:79], v[120:123], a[216:219], v[64:79]
ds_read_b128 v[32:35], v13
ds_read_b128 v[36:39], v14
v_add_u32_sdwa v13, v25, s53 dst_sel:DWORD dst_unused:UNUSED_PAD src0_sel:WORD_0 src1_sel:DWORD
v_add_u32_sdwa v14, v25, s53 dst_sel:DWORD dst_unused:UNUSED_PAD src0_sel:WORD_1 src1_sel:DWORD
v_cvt_pk_bf16_f32 v196, v200, v201
v_mfma_f32_32x32x16_bf16 v[64:79], v[124:127], a[220:223], v[64:79]
ds_write_b128 v2, v[88:91] offset:10240
buffer_load_dwordx4 v[176:179], v15, s[4:7], s59 offen offset:64
s_waitcnt lgkmcnt(8)
v_smfmac_f32_16x16x64_bf16 v[212:215], v[8:11], v[40:47], v12
v_cvt_pk_bf16_f32 v197, v202, v203
v_mfma_f32_32x32x16_bf16 v[80:95], v[96:99], a[224:227], 0
ds_read_b128 v[40:43], v13
ds_read_b128 v[44:47], v14
v_add_u32_sdwa v13, v26, s53 dst_sel:DWORD dst_unused:UNUSED_PAD src0_sel:WORD_0 src1_sel:DWORD
v_add_u32_sdwa v14, v26, s53 dst_sel:DWORD dst_unused:UNUSED_PAD src0_sel:WORD_1 src1_sel:DWORD
v_cvt_pk_bf16_f32 v64, v64, v65
v_mfma_f32_32x32x16_bf16 v[80:95], v[100:103], a[228:231], v[80:95]
v_cvt_pk_bf16_f32 v198, v204, v205
v_cvt_pk_bf16_f32 v199, v206, v207
s_add_u32 s47, s46, 4
s_and_b32 s47, s47, 7
s_lshl_b32 s47, s47, 10
s_add_u32 s47, s47, s45
buffer_store_dwordx4 v[192:195], v4, s[20:23], s47 offen offset:0 sc1
buffer_load_dwordx4 v[180:183], v15, s[4:7], s59 offen offset:80
v_cvt_pk_bf16_f32 v65, v66, v67
v_cvt_pk_bf16_f32 v66, v68, v69
v_cvt_pk_bf16_f32 v67, v70, v71
s_waitcnt lgkmcnt(8)
v_smfmac_f32_16x16x64_bf16 v[216:219], v[8:11], v[48:55], v12
v_cvt_pk_bf16_f32 v72, v72, v73
v_mfma_f32_32x32x16_bf16 v[80:95], v[104:107], a[232:235], v[80:95]
ds_read_b128 v[48:51], v13
ds_read_b128 v[52:55], v14
v_add_u32_sdwa v13, v27, s53 dst_sel:DWORD dst_unused:UNUSED_PAD src0_sel:WORD_0 src1_sel:DWORD
v_add_u32_sdwa v14, v27, s53 dst_sel:DWORD dst_unused:UNUSED_PAD src0_sel:WORD_1 src1_sel:DWORD
v_cvt_pk_bf16_f32 v73, v74, v75
v_mfma_f32_32x32x16_bf16 v[80:95], v[108:111], a[236:239], v[80:95]
ds_write_b128 v1, v[64:67] offset:12288
buffer_load_dword v184, v15, s[4:7], s59 offen offset:96
s_waitcnt lgkmcnt(8)
v_smfmac_f32_16x16x64_bf16 v[220:223], v[8:11], v[56:63], v12
v_cvt_pk_bf16_f32 v74, v76, v77
v_mfma_f32_32x32x16_bf16 v[80:95], v[112:115], a[240:243], v[80:95]
ds_read_b128 v[56:59], v13
ds_read_b128 v[60:63], v14
s_waitcnt vmcnt(15)
v_add_u32_sdwa v13, v28, s53 dst_sel:DWORD dst_unused:UNUSED_PAD src0_sel:WORD_0 src1_sel:DWORD
v_add_u32_sdwa v14, v28, s53 dst_sel:DWORD dst_unused:UNUSED_PAD src0_sel:WORD_1 src1_sel:DWORD
v_cvt_pk_bf16_f32 v75, v78, v79
v_mfma_f32_32x32x16_bf16 v[80:95], v[116:119], a[244:247], v[80:95]
buffer_store_dwordx4 v[196:199], v4, s[20:23], s47 offen offset:256 sc1
v_cvt_pk_bf16_f32 v208, v208, v209
v_cvt_pk_bf16_f32 v209, v210, v211
v_cvt_pk_bf16_f32 v210, v212, v213
buffer_load_dwordx4 v[188:191], v15, s[4:7], s59 offen offset:400
s_waitcnt lgkmcnt(8)
v_smfmac_f32_16x16x64_bf16 v[224:227], v[8:11], v[32:39], v12
v_cvt_pk_bf16_f32 v211, v214, v215
v_mfma_f32_32x32x16_bf16 v[80:95], v[120:123], a[248:251], v[80:95]
ds_read_b128 v[32:35], v13
ds_read_b128 v[36:39], v14
v_add_u32_sdwa v13, v29, s53 dst_sel:DWORD dst_unused:UNUSED_PAD src0_sel:WORD_0 src1_sel:DWORD
v_add_u32_sdwa v14, v29, s53 dst_sel:DWORD dst_unused:UNUSED_PAD src0_sel:WORD_1 src1_sel:DWORD
v_cvt_pk_bf16_f32 v212, v216, v217
v_mfma_f32_32x32x16_bf16 v[80:95], v[124:127], a[252:255], v[80:95]
ds_write_b128 v2, v[72:75] offset:12288
s_waitcnt lgkmcnt(8)
v_smfmac_f32_16x16x64_bf16 v[228:231], v[8:11], v[40:47], v12
v_cvt_pk_bf16_f32 v213, v218, v219
s_nop 7
ds_read_b128 v[40:43], v13
ds_read_b128 v[44:47], v14
v_add_u32_sdwa v13, v30, s53 dst_sel:DWORD dst_unused:UNUSED_PAD src0_sel:WORD_0 src1_sel:DWORD
v_add_u32_sdwa v14, v30, s53 dst_sel:DWORD dst_unused:UNUSED_PAD src0_sel:WORD_1 src1_sel:DWORD
v_cvt_pk_bf16_f32 v80, v80, v81
v_cvt_pk_bf16_f32 v214, v220, v221
v_cvt_pk_bf16_f32 v215, v222, v223
s_add_u32 s47, s46, 5
s_and_b32 s47, s47, 7
s_lshl_b32 s47, s47, 10
s_add_u32 s47, s47, s45
buffer_store_dwordx4 v[208:211], v4, s[20:23], s47 offen offset:0 sc1
buffer_load_dwordx4 v[192:195], v15, s[4:7], s59 offen offset:416
buffer_load_dwordx4 v[196:199], v15, s[4:7], s59 offen offset:432
buffer_load_dwordx4 v[200:203], v15, s[4:7], s59 offen offset:448
buffer_load_dwordx4 v[204:207], v15, s[4:7], s59 offen offset:464
v_cvt_pk_bf16_f32 v81, v82, v83
v_cvt_pk_bf16_f32 v82, v84, v85
v_cvt_pk_bf16_f32 v83, v86, v87
v_cvt_pk_bf16_f32 v88, v88, v89
s_waitcnt lgkmcnt(8)
v_smfmac_f32_16x16x64_bf16 v[232:235], v[8:11], v[48:55], v12
v_cvt_pk_bf16_f32 v89, v90, v91
ds_read_b128 v[48:51], v13
ds_read_b128 v[52:55], v14
v_add_u32_sdwa v13, v31, s53 dst_sel:DWORD dst_unused:UNUSED_PAD src0_sel:WORD_0 src1_sel:DWORD
v_add_u32_sdwa v14, v31, s53 dst_sel:DWORD dst_unused:UNUSED_PAD src0_sel:WORD_1 src1_sel:DWORD
v_cvt_pk_bf16_f32 v90, v92, v93
ds_write_b128 v1, v[80:83] offset:14336
s_waitcnt lgkmcnt(8)
v_smfmac_f32_16x16x64_bf16 v[236:239], v[8:11], v[56:63], v12
v_cvt_pk_bf16_f32 v91, v94, v95
ds_read_b128 v[56:59], v13
ds_read_b128 v[60:63], v14
s_xor_b32 s53, s53, 0x10000
s_and_b32 s53, s53, 0x10000
s_waitcnt vmcnt(19)
v_add_u32_sdwa v13, v16, s53 dst_sel:DWORD dst_unused:UNUSED_PAD src0_sel:WORD_0 src1_sel:DWORD
v_add_u32_sdwa v14, v16, s53 dst_sel:DWORD dst_unused:UNUSED_PAD src0_sel:WORD_1 src1_sel:DWORD
ds_write_b128 v2, v[88:91] offset:14336
buffer_store_dwordx4 v[212:215], v4, s[20:23], s47 offen offset:256 sc1
s_waitcnt lgkmcnt(9)
v_smfmac_f32_16x16x64_bf16 v[240:243], v[8:11], v[32:39], v12
s_waitcnt lgkmcnt(0)
s_barrier
ds_read_b128 v[32:35], v13
ds_read_b128 v[36:39], v14
v_add_u32_sdwa v13, v17, s53 dst_sel:DWORD dst_unused:UNUSED_PAD src0_sel:WORD_0 src1_sel:DWORD
v_add_u32_sdwa v14, v17, s53 dst_sel:DWORD dst_unused:UNUSED_PAD src0_sel:WORD_1 src1_sel:DWORD
ds_read_b128 v[124:127], v3 offset:15360
ds_read_b128 v[120:123], v3 offset:14336
ds_read_b128 v[116:119], v3 offset:13312
ds_read_b128 v[112:115], v3 offset:12288
v_smfmac_f32_16x16x64_bf16 v[244:247], v[8:11], v[40:47], v12
ds_read_b128 v[40:43], v13
ds_read_b128 v[44:47], v14
v_add_u32_sdwa v13, v18, s53 dst_sel:DWORD dst_unused:UNUSED_PAD src0_sel:WORD_0 src1_sel:DWORD
v_add_u32_sdwa v14, v18, s53 dst_sel:DWORD dst_unused:UNUSED_PAD src0_sel:WORD_1 src1_sel:DWORD
ds_read_b128 v[108:111], v3 offset:11264
ds_read_b128 v[104:107], v3 offset:10240
ds_read_b128 v[100:103], v3 offset:9216
ds_read_b128 v[96:99], v3 offset:8192
buffer_load_dwordx4 v[208:211], v15, s[4:7], s59 offen offset:480
buffer_load_dword v212, v15, s[4:7], s59 offen offset:496
v_smfmac_f32_16x16x64_bf16 v[248:251], v[8:11], v[48:55], v12
ds_read_b128 v[48:51], v13
ds_read_b128 v[52:55], v14
v_add_u32_sdwa v13, v19, s53 dst_sel:DWORD dst_unused:UNUSED_PAD src0_sel:WORD_0 src1_sel:DWORD
v_add_u32_sdwa v14, v19, s53 dst_sel:DWORD dst_unused:UNUSED_PAD src0_sel:WORD_1 src1_sel:DWORD
ds_read_b128 v[92:95], v3 offset:7168
ds_read_b128 v[88:91], v3 offset:6144
ds_read_b128 v[84:87], v3 offset:5120
ds_read_b128 v[80:83], v3 offset:4096
v_smfmac_f32_16x16x64_bf16 v[252:255], v[8:11], v[56:63], v12
s_barrier
ds_read_b128 v[56:59], v13
ds_read_b128 v[60:63], v14
s_waitcnt vmcnt(17)
v_add_u32_sdwa v13, v20, s53 dst_sel:DWORD dst_unused:UNUSED_PAD src0_sel:WORD_0 src1_sel:DWORD
v_add_u32_sdwa v14, v20, s53 dst_sel:DWORD dst_unused:UNUSED_PAD src0_sel:WORD_1 src1_sel:DWORD
ds_read_b128 v[76:79], v3 offset:3072
ds_read_b128 v[72:75], v3 offset:2048
ds_read_b128 v[68:71], v3 offset:1024
ds_read_b128 v[64:67], v3 offset:0
s_add_u32 m0, s57, 12288
v_lshl_add_u32 v160, v160, 8, v128
buffer_load_dwordx4 v160, s[8:11], 0 offen offset:0 lds
v_lshl_add_u32 v161, v161, 8, v129
buffer_load_dwordx4 v161, s[8:11], 0 offen offset:1024 lds
v_lshl_add_u32 v162, v162, 8, v130
buffer_load_dwordx4 v162, s[8:11], 0 offen offset:2048 lds
v_lshl_add_u32 v163, v163, 8, v131
buffer_load_dwordx4 v163, s[8:11], 0 offen offset:3072 lds
s_waitcnt lgkmcnt(14)
v_smfmac_f32_16x16x64_bf16 v[224:227], v[8:11], v[32:39], v12
ds_read_b128 v[32:35], v13
ds_read_b128 v[36:39], v14
v_add_u32_sdwa v13, v21, s53 dst_sel:DWORD dst_unused:UNUSED_PAD src0_sel:WORD_0 src1_sel:DWORD
v_add_u32_sdwa v14, v21, s53 dst_sel:DWORD dst_unused:UNUSED_PAD src0_sel:WORD_1 src1_sel:DWORD
s_add_u32 m0, s57, 8192
v_lshl_add_u32 v164, v164, 8, v128
buffer_load_dwordx4 v164, s[8:11], 0 offen offset:0 lds
v_lshl_add_u32 v165, v165, 8, v129
buffer_load_dwordx4 v165, s[8:11], 0 offen offset:1024 lds
v_lshl_add_u32 v166, v166, 8, v130
buffer_load_dwordx4 v166, s[8:11], 0 offen offset:2048 lds
v_lshl_add_u32 v167, v167, 8, v131
buffer_load_dwordx4 v167, s[8:11], 0 offen offset:3072 lds
s_waitcnt lgkmcnt(14)
v_smfmac_f32_16x16x64_bf16 v[228:231], v[8:11], v[40:47], v12
ds_read_b128 v[40:43], v13
ds_read_b128 v[44:47], v14
v_add_u32_sdwa v13, v22, s53 dst_sel:DWORD dst_unused:UNUSED_PAD src0_sel:WORD_0 src1_sel:DWORD
v_add_u32_sdwa v14, v22, s53 dst_sel:DWORD dst_unused:UNUSED_PAD src0_sel:WORD_1 src1_sel:DWORD
s_waitcnt vmcnt(24)
s_add_u32 m0, s57, 4096
v_lshl_add_u32 v168, v168, 8, v128
buffer_load_dwordx4 v168, s[8:11], 0 offen offset:0 lds
v_lshl_add_u32 v169, v169, 8, v129
buffer_load_dwordx4 v169, s[8:11], 0 offen offset:1024 lds
v_lshl_add_u32 v170, v170, 8, v130
buffer_load_dwordx4 v170, s[8:11], 0 offen offset:2048 lds
v_lshl_add_u32 v171, v171, 8, v131
buffer_load_dwordx4 v171, s[8:11], 0 offen offset:3072 lds
s_waitcnt lgkmcnt(14)
v_smfmac_f32_16x16x64_bf16 v[232:235], v[8:11], v[48:55], v12
ds_read_b128 v[48:51], v13
ds_read_b128 v[52:55], v14
v_add_u32_sdwa v13, v23, s53 dst_sel:DWORD dst_unused:UNUSED_PAD src0_sel:WORD_0 src1_sel:DWORD
v_add_u32_sdwa v14, v23, s53 dst_sel:DWORD dst_unused:UNUSED_PAD src0_sel:WORD_1 src1_sel:DWORD
s_waitcnt vmcnt(26)
s_add_u32 m0, s57, 0
v_lshl_add_u32 v172, v172, 8, v128
buffer_load_dwordx4 v172, s[8:11], 0 offen offset:0 lds
v_lshl_add_u32 v173, v173, 8, v129
buffer_load_dwordx4 v173, s[8:11], 0 offen offset:1024 lds
v_lshl_add_u32 v174, v174, 8, v130
buffer_load_dwordx4 v174, s[8:11], 0 offen offset:2048 lds
v_lshl_add_u32 v175, v175, 8, v131
buffer_load_dwordx4 v175, s[8:11], 0 offen offset:3072 lds
s_waitcnt lgkmcnt(10)
v_smfmac_f32_16x16x64_bf16 v[236:239], v[8:11], v[56:63], v12
ds_read_b128 v[56:59], v13
ds_read_b128 v[60:63], v14
s_waitcnt lgkmcnt(6)
v_smfmac_f32_16x16x64_bf16 v[240:243], v[8:11], v[32:39], v12
s_waitcnt vmcnt(12)
ds_read_b128 a[0:3], v132 offset:12288
ds_read_b128 a[4:7], v133 offset:12288
s_waitcnt lgkmcnt(6)
v_smfmac_f32_16x16x64_bf16 v[244:247], v[8:11], v[40:47], v12
ds_read_b128 a[8:11], v134 offset:12288
ds_read_b128 a[12:15], v135 offset:12288
s_waitcnt lgkmcnt(6)
v_smfmac_f32_16x16x64_bf16 v[248:251], v[8:11], v[48:55], v12
s_waitcnt vmcnt(8)
ds_read_b128 a[16:19], v132 offset:8192
ds_read_b128 a[20:23], v133 offset:8192
s_waitcnt lgkmcnt(6)
v_smfmac_f32_16x16x64_bf16 v[252:255], v[8:11], v[56:63], v12
s_barrier
L_RERUN:
s_add_u32 s12, s82, 1052672
s_addc_u32 s13, s83, 0
s_mov_b32 s14, 4096
s_mov_b32 s15, 0x20000
s_nop 3
v_cvt_pk_bf16_f32 v224, v224, v225
v_cvt_pk_bf16_f32 v225, v226, v227
v_cvt_pk_bf16_f32 v226, v228, v229
v_cvt_pk_bf16_f32 v227, v230, v231
v_cvt_pk_bf16_f32 v228, v232, v233
v_cvt_pk_bf16_f32 v229, v234, v235
v_cvt_pk_bf16_f32 v230, v236, v237
v_cvt_pk_bf16_f32 v231, v238, v239
v_cvt_pk_bf16_f32 v240, v240, v241
v_cvt_pk_bf16_f32 v241, v242, v243
v_cvt_pk_bf16_f32 v242, v244, v245
v_cvt_pk_bf16_f32 v243, v246, v247
v_cvt_pk_bf16_f32 v244, v248, v249
v_cvt_pk_bf16_f32 v245, v250, v251
v_cvt_pk_bf16_f32 v246, v252, v253
v_cvt_pk_bf16_f32 v247, v254, v255
s_add_u32 s47, s46, 6
s_and_b32 s47, s47, 7
s_lshl_b32 s47, s47, 10
s_add_u32 s47, s47, s45
buffer_store_dwordx4 v[224:227], v4, s[20:23], s47 offen offset:0 sc1
buffer_store_dwordx4 v[228:231], v4, s[20:23], s47 offen offset:256 sc1
s_add_u32 s47, s46, 7
s_and_b32 s47, s47, 7
s_lshl_b32 s47, s47, 10
s_add_u32 s47, s47, s45
buffer_store_dwordx4 v[240:243], v4, s[20:23], s47 offen offset:0 sc1
buffer_store_dwordx4 v[244:247], v4, s[20:23], s47 offen offset:256 sc1
s_waitcnt lgkmcnt(2)
v_mfma_f32_16x16x32_bf16 v[144:147], a[0:3], a[0:3], 0
buffer_load_dwordx4 v[160:163], v15, s[4:7], s59 offen offset:800
v_mfma_f32_16x16x32_bf16 v[144:147], a[4:7], a[4:7], v[144:147]
buffer_load_dwordx4 v[164:167], v15, s[4:7], s59 offen offset:816
v_mfma_f32_16x16x32_bf16 v[144:147], a[8:11], a[8:11], v[144:147]
buffer_load_dwordx4 v[168:171], v15, s[4:7], s59 offen offset:832
v_mfma_f32_16x16x32_bf16 v[144:147], a[12:15], a[12:15], v[144:147]
buffer_load_dwordx4 v[172:175], v15, s[4:7], s59 offen offset:848
s_add_u32 m0, s51, 12288
v_lshl_add_u32 v176, v176, 8, v128
buffer_load_dwordx4 v176, s[8:11], 0 offen offset:0 lds
ds_read_b128 a[24:27], v134 offset:8192
ds_read_b128 a[28:31], v135 offset:8192
s_waitcnt lgkmcnt(0)
v_mfma_f32_16x16x32_bf16 v[148:151], a[0:3], a[16:19], 0
v_lshl_add_u32 v177, v177, 8, v129
v_mfma_f32_16x16x32_bf16 v[148:151], a[4:7], a[20:23], v[148:151]
buffer_load_dwordx4 v177, s[8:11], 0 offen offset:1024 lds
s_waitcnt vmcnt(14)
v_mfma_f32_16x16x32_bf16 v[148:151], a[8:11], a[24:27], v[148:151]
ds_read_b128 a[32:35], v132 offset:4096
v_mfma_f32_16x16x32_bf16 v[148:151], a[12:15], a[28:31], v[148:151]
ds_read_b128 a[36:39], v133 offset:4096
v_mfma_f32_16x16x32_bf16 v[152:155], a[16:19], a[16:19], 0
v_mul_f32 v1, v144, v64
v_lshl_add_u32 v178, v178, 8, v130
v_mfma_f32_16x16x32_bf16 v[152:155], a[20:23], a[20:23], v[152:155]
buffer_load_dwordx4 v178, s[8:11], 0 offen offset:2048 lds
v_mul_f32 v2, v145, v65
v_mfma_f32_16x16x32_bf16 v[152:155], a[24:27], a[24:27], v[152:155]
ds_read_b128 a[40:43], v134 offset:4096
v_mul_f32 v13, v146, v66
v_mfma_f32_16x16x32_bf16 v[152:155], a[28:31], a[28:31], v[152:155]
ds_read_b128 a[44:47], v135 offset:4096
v_mul_f32 v14, v147, v67
s_waitcnt lgkmcnt(0)
v_mfma_f32_16x16x32_bf16 v[156:159], a[0:3], a[32:35], 0
v_fmac_f32 v1, v148, v68
v_lshl_add_u32 v179, v179, 8, v131
v_mfma_f32_16x16x32_bf16 v[156:159], a[4:7], a[36:39], v[156:159]
buffer_load_dwordx4 v179, s[8:11], 0 offen offset:3072 lds
v_fmac_f32 v2, v149, v69
v_mfma_f32_16x16x32_bf16 v[156:159], a[8:11], a[40:43], v[156:159]
s_waitcnt vmcnt(12)
v_fmac_f32 v13, v150, v70
v_fmac_f32 v14, v151, v71
v_mfma_f32_16x16x32_bf16 v[156:159], a[12:15], a[44:47], v[156:159]
ds_read_b128 a[48:51], v132 offset:0
v_mfma_f32_16x16x32_bf16 v[144:147], a[16:19], a[32:35], 0
ds_read_b128 a[52:55], v133 offset:0
v_fmac_f32 v1, v152, v72
v_mfma_f32_16x16x32_bf16 v[144:147], a[20:23], a[36:39], v[144:147]
buffer_load_dwordx4 v[176:179], v15, s[4:7], s59 offen offset:864
v_fmac_f32 v2, v153, v73
v_mfma_f32_16x16x32_bf16 v[144:147], a[24:27], a[40:43], v[144:147]
v_fmac_f32 v13, v154, v74
s_add_u32 m0, s51, 8192
v_mfma_f32_16x16x32_bf16 v[144:147], a[28:31], a[44:47], v[144:147]
v_fmac_f32 v14, v155, v75
v_lshl_add_u32 v180, v180, 8, v128
v_mfma_f32_16x16x32_bf16 v[148:151], a[32:35], a[32:35], 0
buffer_load_dwordx4 v180, s[8:11], 0 offen offset:0 lds
v_fmac_f32 v1, v156, v76
v_mfma_f32_16x16x32_bf16 v[148:151], a[36:39], a[36:39], v[148:151]
ds_read_b128 a[56:59], v134 offset:0
v_fmac_f32 v2, v157, v77
v_mfma_f32_16x16x32_bf16 v[148:151], a[40:43], a[40:43], v[148:151]
ds_read_b128 a[60:63], v135 offset:0
v_fmac_f32 v13, v158, v78
v_mfma_f32_16x16x32_bf16 v[148:151], a[44:47], a[44:47], v[148:151]
ds_read_b128 v[16:19], v3 offset:16384
v_fmac_f32 v14, v159, v79
s_waitcnt lgkmcnt(1)
v_mfma_f32_16x16x32_bf16 v[152:155], a[0:3], a[48:51], 0
v_fmac_f32 v1, v144, v80
v_lshl_add_u32 v181, v181, 8, v129
v_mfma_f32_16x16x32_bf16 v[152:155], a[4:7], a[52:55], v[152:155]
buffer_load_dwordx4 v181, s[8:11], 0 offen offset:1024 lds
v_fmac_f32 v2, v145, v81
v_mfma_f32_16x16x32_bf16 v[152:155], a[8:11], a[56:59], v[152:155]
ds_read_b128 v[20:23], v3 offset:17408
v_fmac_f32 v13, v146, v82
v_mfma_f32_16x16x32_bf16 v[152:155], a[12:15], a[60:63], v[152:155]
v_fmac_f32 v14, v147, v83
v_lshl_add_u32 v182, v182, 8, v130
v_mfma_f32_16x16x32_bf16 v[156:159], a[16:19], a[48:51], 0
buffer_load_dwordx4 v182, s[8:11], 0 offen offset:2048 lds
v_fmac_f32 v1, v148, v84
v_mfma_f32_16x16x32_bf16 v[156:159], a[20:23], a[52:55], v[156:159]
ds_read_b128 v[24:27], v3 offset:18432
v_fmac_f32 v2, v149, v85
v_mfma_f32_16x16x32_bf16 v[156:159], a[24:27], a[56:59], v[156:159]
v_fmac_f32 v13, v150, v86
v_lshl_add_u32 v183, v183, 8, v131
v_mfma_f32_16x16x32_bf16 v[156:159], a[28:31], a[60:63], v[156:159]
buffer_load_dwordx4 v183, s[8:11], 0 offen offset:3072 lds
v_fmac_f32 v14, v151, v87
v_mfma_f32_16x16x32_bf16 v[144:147], a[32:35], a[48:51], 0
s_waitcnt vmcnt(5)
v_fmac_f32 v1, v152, v88
v_fmac_f32 v2, v153, v89
v_mfma_f32_16x16x32_bf16 v[144:147], a[36:39], a[52:55], v[144:147]
ds_read_b128 a[64:67], v136 offset:12288
v_fmac_f32 v13, v154, v90
v_mfma_f32_16x16x32_bf16 v[144:147], a[40:43], a[56:59], v[144:147]
ds_read_b128 a[68:71], v137 offset:12288
v_fmac_f32 v14, v155, v91
v_mfma_f32_16x16x32_bf16 v[144:147], a[44:47], a[60:63], v[144:147]
ds_read_b128 v[28:31], v3 offset:19456
v_mfma_f32_16x16x32_bf16 v[148:151], a[48:51], a[48:51], 0
buffer_load_dwordx4 v[180:183], v15, s[4:7], s59 offen offset:880
v_fmac_f32 v1, v156, v92
v_mfma_f32_16x16x32_bf16 v[148:151], a[52:55], a[52:55], v[148:151]
v_fmac_f32 v2, v157, v93
v_mfma_f32_16x16x32_bf16 v[148:151], a[56:59], a[56:59], v[148:151]
s_add_u32 m0, s57, 12288
v_fmac_f32 v13, v158, v94
v_lshl_add_u32 v184, v184, 8, v128
v_mfma_f32_16x16x32_bf16 v[148:151], a[60:63], a[60:63], v[148:151]
buffer_load_dwordx4 v184, s[8:11], 0 offen offset:0 lds
v_fmac_f32 v14, v159, v95
ds_read_b128 a[72:75], v138 offset:12288
ds_read_b128 a[76:79], v139 offset:12288
ds_read_b128 v[32:35], v3 offset:20480
s_waitcnt lgkmcnt(1)
v_mfma_f32_16x16x32_bf16 v[152:155], a[0:3], a[64:67], 0
buffer_load_dword v184, v15, s[4:7], s59 offen offset:896
v_fmac_f32 v1, v144, v96
v_mfma_f32_16x16x32_bf16 v[152:155], a[4:7], a[68:71], v[152:155]
v_fmac_f32 v2, v145, v97
s_add_u32 m0, s51, 4096
v_mfma_f32_16x16x32_bf16 v[152:155], a[8:11], a[72:75], v[152:155]
v_fmac_f32 v13, v146, v98
v_lshl_add_u32 v188, v188, 8, v128
v_mfma_f32_16x16x32_bf16 v[152:155], a[12:15], a[76:79], v[152:155]
buffer_load_dwordx4 v188, s[8:11], 0 offen offset:0 lds
v_fmac_f32 v14, v147, v99
ds_read_b128 v[36:39], v3 offset:21504
v_mfma_f32_16x16x32_bf16 v[156:159], a[16:19], a[64:67], 0
v_fmac_f32 v1, v148, v100
v_lshl_add_u32 v189, v189, 8, v129
v_mfma_f32_16x16x32_bf16 v[156:159], a[20:23], a[68:71], v[156:159]
buffer_load_dwordx4 v189, s[8:11], 0 offen offset:1024 lds
v_fmac_f32 v2, v149, v101
v_mfma_f32_16x16x32_bf16 v[156:159], a[24:27], a[72:75], v[156:159]
ds_read_b128 v[40:43], v3 offset:22528
v_fmac_f32 v13, v150, v102
v_mfma_f32_16x16x32_bf16 v[156:159], a[28:31], a[76:79], v[156:159]
v_fmac_f32 v14, v151, v103
v_lshl_add_u32 v190, v190, 8, v130
v_mfma_f32_16x16x32_bf16 v[144:147], a[32:35], a[64:67], 0
buffer_load_dwordx4 v190, s[8:11], 0 offen offset:2048 lds
v_fmac_f32 v1, v152, v104
v_mfma_f32_16x16x32_bf16 v[144:147], a[36:39], a[68:71], v[144:147]
ds_read_b128 v[44:47], v3 offset:23552
v_fmac_f32 v2, v153, v105
v_mfma_f32_16x16x32_bf16 v[144:147], a[40:43], a[72:75], v[144:147]
v_fmac_f32 v13, v154, v106
v_lshl_add_u32 v191, v191, 8, v131
v_mfma_f32_16x16x32_bf16 v[144:147], a[44:47], a[76:79], v[144:147]
buffer_load_dwordx4 v191, s[8:11], 0 offen offset:3072 lds
v_fmac_f32 v14, v155, v107
v_mfma_f32_16x16x32_bf16 v[148:151], a[48:51], a[64:67], 0
s_waitcnt vmcnt(7)
v_fmac_f32 v1, v156, v108
v_fmac_f32 v2, v157, v109
v_mfma_f32_16x16x32_bf16 v[148:151], a[52:55], a[68:71], v[148:151]
ds_read_b128 a[80:83], v136 offset:8192
v_fmac_f32 v13, v158, v110
v_mfma_f32_16x16x32_bf16 v[148:151], a[56:59], a[72:75], v[148:151]
ds_read_b128 a[84:87], v137 offset:8192
v_fmac_f32 v14, v159, v111
v_mfma_f32_16x16x32_bf16 v[148:151], a[60:63], a[76:79], v[148:151]
ds_read_b128 v[48:51], v3 offset:24576
v_mfma_f32_16x16x32_bf16 v[152:155], a[64:67], a[64:67], 0
buffer_load_dwordx4 v[188:191], v15, s[4:7], s59 offen offset:1200
v_fmac_f32 v1, v144, v112
v_mfma_f32_16x16x32_bf16 v[152:155], a[68:71], a[68:71], v[152:155]
v_fmac_f32 v2, v145, v113
v_mfma_f32_16x16x32_bf16 v[152:155], a[72:75], a[72:75], v[152:155]
s_add_u32 m0, s51, 12288
v_fmac_f32 v13, v146, v114
v_lshl_add_u32 v192, v192, 8, v128
v_mfma_f32_16x16x32_bf16 v[152:155], a[76:79], a[76:79], v[152:155]
buffer_load_dwordx4 v192, s[8:11], 0 offen offset:0 lds
v_fmac_f32 v14, v147, v115
ds_read_b128 a[88:91], v138 offset:8192
ds_read_b128 a[92:95], v139 offset:8192
ds_read_b128 v[52:55], v3 offset:25600
s_waitcnt lgkmcnt(1)
v_mfma_f32_16x16x32_bf16 v[156:159], a[0:3], a[80:83], 0
v_fmac_f32 v1, v148, v116
v_lshl_add_u32 v193, v193, 8, v129
v_mfma_f32_16x16x32_bf16 v[156:159], a[4:7], a[84:87], v[156:159]
buffer_load_dwordx4 v193, s[8:11], 0 offen offset:1024 lds
v_fmac_f32 v2, v149, v117
v_mfma_f32_16x16x32_bf16 v[156:159], a[8:11], a[88:91], v[156:159]
ds_read_b128 v[56:59], v3 offset:26624
v_fmac_f32 v13, v150, v118
v_mfma_f32_16x16x32_bf16 v[156:159], a[12:15], a[92:95], v[156:159]
v_fmac_f32 v14, v151, v119
v_lshl_add_u32 v194, v194, 8, v130
v_mfma_f32_16x16x32_bf16 v[144:147], a[16:19], a[80:83], 0
buffer_load_dwordx4 v194, s[8:11], 0 offen offset:2048 lds
v_fmac_f32 v1, v152, v120
v_mfma_f32_16x16x32_bf16 v[144:147], a[20:23], a[84:87], v[144:147]
ds_read_b128 v[60:63], v3 offset:27648
v_fmac_f32 v2, v153, v121
v_mfma_f32_16x16x32_bf16 v[144:147], a[24:27], a[88:91], v[144:147]
v_fmac_f32 v13, v154, v122
v_lshl_add_u32 v195, v195, 8, v131
v_mfma_f32_16x16x32_bf16 v[144:147], a[28:31], a[92:95], v[144:147]
buffer_load_dwordx4 v195, s[8:11], 0 offen offset:3072 lds
v_fmac_f32 v14, v155, v123
v_mfma_f32_16x16x32_bf16 v[148:151], a[32:35], a[80:83], 0
buffer_load_dwordx4 v[192:195], v15, s[4:7], s59 offen offset:1216
v_fmac_f32 v1, v156, v124
v_mfma_f32_16x16x32_bf16 v[148:151], a[36:39], a[84:87], v[148:151]
v_fmac_f32 v2, v157, v125
v_mfma_f32_16x16x32_bf16 v[148:151], a[40:43], a[88:91], v[148:151]
s_add_u32 m0, s51, 8192
v_fmac_f32 v13, v158, v126
v_lshl_add_u32 v196, v196, 8, v128
v_mfma_f32_16x16x32_bf16 v[148:151], a[44:47], a[92:95], v[148:151]
buffer_load_dwordx4 v196, s[8:11], 0 offen offset:0 lds
v_fmac_f32 v14, v159, v127
v_mfma_f32_16x16x32_bf16 v[152:155], a[48:51], a[80:83], 0
v_fmac_f32 v1, v144, v16
v_lshl_add_u32 v197, v197, 8, v129
v_mfma_f32_16x16x32_bf16 v[152:155], a[52:55], a[84:87], v[152:155]
buffer_load_dwordx4 v197, s[8:11], 0 offen offset:1024 lds
v_fmac_f32 v2, v145, v17
v_mfma_f32_16x16x32_bf16 v[152:155], a[56:59], a[88:91], v[152:155]
s_waitcnt vmcnt(13)
v_fmac_f32 v13, v146, v18
v_fmac_f32 v14, v147, v19
v_mfma_f32_16x16x32_bf16 v[152:155], a[60:63], a[92:95], v[152:155]
ds_read_b128 a[96:99], v140 offset:12288
v_mfma_f32_16x16x32_bf16 v[156:159], a[64:67], a[80:83], 0
ds_read_b128 a[100:103], v141 offset:12288
v_fmac_f32 v1, v148, v20
s_barrier
s_or_b32 s44, s3, s61
s_cmp_lg_u32 s44, 0
s_cbranch_scc1 L_sig2
s_lshl_b32 s44, s2, 4
v_mov_b32 v216, s56
v_lshlrev_b32 v217, 20, v7
buffer_store_dword v216, v217, s[12:15], s44 offen sc1
L_sig2:
v_mfma_f32_16x16x32_bf16 v[156:159], a[68:71], a[84:87], v[156:159]
v_fmac_f32 v2, v149, v21
v_lshl_add_u32 v198, v198, 8, v130
v_mfma_f32_16x16x32_bf16 v[156:159], a[72:75], a[88:91], v[156:159]
buffer_load_dwordx4 v198, s[8:11], 0 offen offset:2048 lds
v_fmac_f32 v13, v150, v22
v_mfma_f32_16x16x32_bf16 v[156:159], a[76:79], a[92:95], v[156:159]
ds_read_b128 a[104:107], v142 offset:12288
v_fmac_f32 v14, v151, v23
v_mfma_f32_16x16x32_bf16 v[144:147], a[80:83], a[80:83], 0
ds_read_b128 a[108:111], v143 offset:12288
v_fmac_f32 v1, v152, v24
v_mfma_f32_16x16x32_bf16 v[144:147], a[84:87], a[84:87], v[144:147]
v_fmac_f32 v2, v153, v25
v_lshl_add_u32 v199, v199, 8, v131
v_mfma_f32_16x16x32_bf16 v[144:147], a[88:91], a[88:91], v[144:147]
buffer_load_dwordx4 v199, s[8:11], 0 offen offset:3072 lds
v_fmac_f32 v13, v154, v26
v_mfma_f32_16x16x32_bf16 v[144:147], a[92:95], a[92:95], v[144:147]
v_fmac_f32 v14, v155, v27
s_waitcnt lgkmcnt(0)
v_mfma_f32_16x16x32_bf16 v[148:151], a[0:3], a[96:99], 0
buffer_load_dwordx4 v[196:199], v15, s[4:7], s59 offen offset:1232
v_fmac_f32 v1, v156, v28
v_mfma_f32_16x16x32_bf16 v[148:151], a[4:7], a[100:103], v[148:151]
v_fmac_f32 v2, v157, v29
s_add_u32 m0, s51, 0
v_mfma_f32_16x16x32_bf16 v[148:151], a[8:11], a[104:107], v[148:151]
v_fmac_f32 v13, v158, v30
v_lshl_add_u32 v200, v200, 8, v128
v_mfma_f32_16x16x32_bf16 v[148:151], a[12:15], a[108:111], v[148:151]
buffer_load_dwordx4 v200, s[8:11], 0 offen offset:0 lds
v_fmac_f32 v14, v159, v31
v_mfma_f32_16x16x32_bf16 v[152:155], a[16:19], a[96:99], 0
v_fmac_f32 v1, v144, v32
v_lshl_add_u32 v201, v201, 8, v129
v_mfma_f32_16x16x32_bf16 v[152:155], a[20:23], a[100:103], v[152:155]
buffer_load_dwordx4 v201, s[8:11], 0 offen offset:1024 lds
v_fmac_f32 v2, v145, v33
v_mfma_f32_16x16x32_bf16 v[152:155], a[24:27], a[104:107], v[152:155]
s_waitcnt vmcnt(13)
v_fmac_f32 v13, v146, v34
v_fmac_f32 v14, v147, v35
v_mfma_f32_16x16x32_bf16 v[152:155], a[28:31], a[108:111], v[152:155]
ds_read_b128 a[112:115], v136 offset:4096
v_mfma_f32_16x16x32_bf16 v[156:159], a[32:35], a[96:99], 0
ds_read_b128 a[116:119], v137 offset:4096
v_fmac_f32 v1, v148, v36
v_mfma_f32_16x16x32_bf16 v[156:159], a[36:39], a[100:103], v[156:159]
v_fmac_f32 v2, v149, v37
v_and_b32 v218, 7, v7
v_mfma_f32_16x16x32_bf16 v[156:159], a[40:43], a[104:107], v[156:159]
v_fmac_f32 v13, v150, v38
v_lshlrev_b32 v218, 4, v218
v_mfma_f32_16x16x32_bf16 v[156:159], a[44:47], a[108:111], v[156:159]
v_fmac_f32 v14, v151, v39
v_bfe_u32 v219, v7, 4, 1
v_lshl_add_u32 v218, v219, 22, v218
v_bfe_u32 v219, v7, 3, 1
v_lshrrev_b32 v216, 5, v7
v_lshl_add_u32 v219, v216, 1, v219
v_lshl_add_u32 v218, v219, 18, v218
s_lshl_b32 s44, s3, 8
v_lshl_add_u32 v219, v219, 6, s44
s_mov_b32 s32, s74
s_mov_b32 s33, s75
s_mov_b32 s34, 1024
s_mov_b32 s35, 0x20000
v_mfma_f32_16x16x32_bf16 v[144:147], a[48:51], a[96:99], 0
v_fmac_f32 v1, v152, v40
v_lshl_add_u32 v202, v202, 8, v130
v_mfma_f32_16x16x32_bf16 v[144:147], a[52:55], a[100:103], v[144:147]
buffer_load_dwordx4 v202, s[8:11], 0 offen offset:2048 lds
v_fmac_f32 v2, v153, v41
v_mfma_f32_16x16x32_bf16 v[144:147], a[56:59], a[104:107], v[144:147]
ds_read_b128 a[120:123], v138 offset:4096
v_fmac_f32 v13, v154, v42
v_mfma_f32_16x16x32_bf16 v[144:147], a[60:63], a[108:111], v[144:147]
ds_read_b128 a[124:127], v139 offset:4096
v_fmac_f32 v14, v155, v43
v_mfma_f32_16x16x32_bf16 v[148:151], a[64:67], a[96:99], 0
v_fmac_f32 v1, v156, v44
v_lshl_add_u32 v203, v203, 8, v131
v_mfma_f32_16x16x32_bf16 v[148:151], a[68:71], a[100:103], v[148:151]
buffer_load_dwordx4 v203, s[8:11], 0 offen offset:3072 lds
v_fmac_f32 v2, v157, v45
v_mfma_f32_16x16x32_bf16 v[148:151], a[72:75], a[104:107], v[148:151]
buffer_load_dwordx4 v[200:203], v15, s[4:7], s59 offen offset:1248
v_fmac_f32 v13, v158, v46
v_mfma_f32_16x16x32_bf16 v[148:151], a[76:79], a[108:111], v[148:151]
v_fmac_f32 v14, v159, v47
v_mfma_f32_16x16x32_bf16 v[152:155], a[80:83], a[96:99], 0
s_add_u32 m0, s57, 12288
v_fmac_f32 v1, v144, v48
v_lshl_add_u32 v204, v204, 8, v128
v_mfma_f32_16x16x32_bf16 v[152:155], a[84:87], a[100:103], v[152:155]
buffer_load_dwordx4 v204, s[8:11], 0 offen offset:0 lds
v_fmac_f32 v2, v145, v49
v_mfma_f32_16x16x32_bf16 v[152:155], a[88:91], a[104:107], v[152:155]
v_fmac_f32 v13, v146, v50
v_lshl_add_u32 v205, v205, 8, v129
v_mfma_f32_16x16x32_bf16 v[152:155], a[92:95], a[108:111], v[152:155]
buffer_load_dwordx4 v205, s[8:11], 0 offen offset:1024 lds
v_fmac_f32 v14, v147, v51
v_mfma_f32_16x16x32_bf16 v[156:159], a[96:99], a[96:99], 0
s_waitcnt vmcnt(13)
v_fmac_f32 v1, v148, v52
v_fmac_f32 v2, v149, v53
v_mfma_f32_16x16x32_bf16 v[156:159], a[100:103], a[100:103], v[156:159]
ds_read_b128 a[128:131], v136 offset:12288
v_fmac_f32 v13, v150, v54
v_mfma_f32_16x16x32_bf16 v[156:159], a[104:107], a[104:107], v[156:159]
ds_read_b128 a[132:135], v137 offset:12288
v_fmac_f32 v14, v151, v55
v_mfma_f32_16x16x32_bf16 v[156:159], a[108:111], a[108:111], v[156:159]
buffer_load_dwordx4 v[240:243], v219, s[32:35], 0 offen offset:0
buffer_load_dwordx4 v[244:247], v219, s[32:35], 0 offen offset:16
buffer_load_dwordx4 v[248:251], v219, s[32:35], 0 offen offset:32
buffer_load_dwordx4 v[252:255], v219, s[32:35], 0 offen offset:48
s_mov_b32 s28, s76
s_mov_b32 s29, s77
s_mov_b32 s30, 2
s_mov_b32 s31, 0x20000
v_mov_b32 v216, 0
buffer_load_ushort v217, v216, s[28:31], 0 offen
s_mov_b32 s32, s78
s_mov_b32 s33, s79
s_mov_b32 s34, 8192
s_mov_b32 s35, 0x20000
s_mov_b32 s45, 0xbdd2d3e8
v_mov_b32 v219, 0xc0135761
v_mov_b32 v4, 0
s_waitcnt lgkmcnt(2)
v_mfma_f32_16x16x32_bf16 v[144:147], a[112:115], a[112:115], 0
v_fmac_f32 v1, v152, v56
v_lshl_add_u32 v206, v206, 8, v130
v_mfma_f32_16x16x32_bf16 v[144:147], a[116:119], a[116:119], v[144:147]
buffer_load_dwordx4 v206, s[8:11], 0 offen offset:2048 lds
v_fmac_f32 v2, v153, v57
v_mfma_f32_16x16x32_bf16 v[144:147], a[120:123], a[120:123], v[144:147]
ds_read_b128 a[136:139], v138 offset:12288
v_fmac_f32 v13, v154, v58
v_mfma_f32_16x16x32_bf16 v[144:147], a[124:127], a[124:127], v[144:147]
ds_read_b128 a[140:143], v139 offset:12288
v_fmac_f32 v14, v155, v59
s_waitcnt lgkmcnt(0)
v_mfma_f32_16x16x32_bf16 v[148:151], a[112:115], a[128:131], 0
v_fmac_f32 v1, v156, v60
v_fmac_f32 v2, v157, v61
v_mfma_f32_16x16x32_bf16 v[148:151], a[116:119], a[132:135], v[148:151]
v_fmac_f32 v13, v158, v62
v_fmac_f32 v14, v159, v63
v_mfma_f32_16x16x32_bf16 v[148:151], a[120:123], a[136:139], v[148:151]
v_add_f32 v1, v1, v2
v_add_f32 v13, v13, v14
v_mfma_f32_16x16x32_bf16 v[148:151], a[124:127], a[140:143], v[148:151]
v_add_f32 v1, v1, v13
v_accvgpr_write_b32 a252, v1
v_lshl_add_u32 v207, v207, 8, v131
buffer_load_dwordx4 v207, s[8:11], 0 offen offset:3072 lds
s_waitcnt vmcnt(15)
ds_read_b128 a[144:147], v136 offset:8192
ds_read_b128 a[148:151], v137 offset:8192
v_mfma_f32_16x16x32_bf16 v[152:155], a[128:131], a[128:131], 0
buffer_load_dwordx4 v[204:207], v15, s[4:7], s59 offen offset:1264
v_mul_f32 v1, v144, v64
v_mfma_f32_16x16x32_bf16 v[152:155], a[132:135], a[132:135], v[152:155]
v_mul_f32 v2, v145, v65
v_mfma_f32_16x16x32_bf16 v[152:155], a[136:139], a[136:139], v[152:155]
s_add_u32 m0, s51, 4096
v_mul_f32 v13, v146, v66
v_lshl_add_u32 v208, v208, 8, v128
v_mfma_f32_16x16x32_bf16 v[152:155], a[140:143], a[140:143], v[152:155]
buffer_load_dwordx4 v208, s[8:11], 0 offen offset:0 lds
v_mul_f32 v14, v147, v67
ds_read_b128 a[152:155], v138 offset:8192
ds_read_b128 a[156:159], v139 offset:8192
s_waitcnt lgkmcnt(0)
v_mfma_f32_16x16x32_bf16 v[156:159], a[112:115], a[144:147], 0
v_fmac_f32 v1, v148, v68
v_lshl_add_u32 v209, v209, 8, v129
v_mfma_f32_16x16x32_bf16 v[156:159], a[116:119], a[148:151], v[156:159]
buffer_load_dwordx4 v209, s[8:11], 0 offen offset:1024 lds
v_fmac_f32 v2, v149, v69
v_mfma_f32_16x16x32_bf16 v[156:159], a[120:123], a[152:155], v[156:159]
v_fmac_f32 v13, v150, v70
v_lshl_add_u32 v210, v210, 8, v130
v_mfma_f32_16x16x32_bf16 v[156:159], a[124:127], a[156:159], v[156:159]
buffer_load_dwordx4 v210, s[8:11], 0 offen offset:2048 lds
v_fmac_f32 v14, v151, v71
v_mfma_f32_16x16x32_bf16 v[144:147], a[128:131], a[144:147], 0
s_waitcnt vmcnt(14)
v_fmac_f32 v1, v152, v72
v_fmac_f32 v2, v153, v73
v_mfma_f32_16x16x32_bf16 v[144:147], a[132:135], a[148:151], v[144:147]
ds_read_b128 a[160:163], v136 offset:0
v_fmac_f32 v13, v154, v74
v_mfma_f32_16x16x32_bf16 v[144:147], a[136:139], a[152:155], v[144:147]
ds_read_b128 a[164:167], v137 offset:0
v_fmac_f32 v14, v155, v75
v_mfma_f32_16x16x32_bf16 v[144:147], a[140:143], a[156:159], v[144:147]
v_lshl_add_u32 v211, v211, 8, v131
v_mfma_f32_16x16x32_bf16 v[148:151], a[144:147], a[144:147], 0
buffer_load_dwordx4 v211, s[8:11], 0 offen offset:3072 lds
v_fmac_f32 v1, v156, v76
v_mfma_f32_16x16x32_bf16 v[148:151], a[148:151], a[148:151], v[148:151]
ds_read_b128 a[168:171], v138 offset:0
v_fmac_f32 v2, v157, v77
v_mfma_f32_16x16x32_bf16 v[148:151], a[152:155], a[152:155], v[148:151]
ds_read_b128 a[172:175], v139 offset:0
v_fmac_f32 v13, v158, v78
v_mfma_f32_16x16x32_bf16 v[148:151], a[156:159], a[156:159], v[148:151]
buffer_load_dwordx4 v[208:211], v15, s[4:7], s59 offen offset:1280
v_fmac_f32 v14, v159, v79
s_waitcnt lgkmcnt(0)
v_mfma_f32_16x16x32_bf16 v[152:155], a[112:115], a[160:163], 0
v_fmac_f32 v1, v144, v80
v_mfma_f32_16x16x32_bf16 v[152:155], a[116:119], a[164:167], v[152:155]
s_add_u32 m0, s57, 8192
v_fmac_f32 v2, v145, v81
v_lshl_add_u32 v212, v212, 8, v128
v_mfma_f32_16x16x32_bf16 v[152:155], a[120:123], a[168:171], v[152:155]
buffer_load_dwordx4 v212, s[8:11], 0 offen offset:0 lds
v_fmac_f32 v13, v146, v82
v_mfma_f32_16x16x32_bf16 v[152:155], a[124:127], a[172:175], v[152:155]
buffer_load_dword v212, v15, s[4:7], s59 offen offset:1296
v_fmac_f32 v14, v147, v83
v_mfma_f32_16x16x32_bf16 v[156:159], a[128:131], a[160:163], 0
v_fmac_f32 v1, v148, v84
v_mfma_f32_16x16x32_bf16 v[156:159], a[132:135], a[164:167], v[156:159]
s_add_u32 m0, s51, 12288
v_fmac_f32 v2, v149, v85
v_lshl_add_u32 v160, v160, 8, v128
v_mfma_f32_16x16x32_bf16 v[156:159], a[136:139], a[168:171], v[156:159]
buffer_load_dwordx4 v160, s[8:11], 0 offen offset:0 lds
v_fmac_f32 v13, v150, v86
v_mfma_f32_16x16x32_bf16 v[156:159], a[140:143], a[172:175], v[156:159]
v_fmac_f32 v14, v151, v87
v_lshl_add_u32 v161, v161, 8, v129
v_mfma_f32_16x16x32_bf16 v[144:147], a[144:147], a[160:163], 0
buffer_load_dwordx4 v161, s[8:11], 0 offen offset:1024 lds
v_fmac_f32 v1, v152, v88
v_mfma_f32_16x16x32_bf16 v[144:147], a[148:151], a[164:167], v[144:147]
s_waitcnt vmcnt(10)
v_fmac_f32 v2, v153, v89
v_fmac_f32 v13, v154, v90
v_mfma_f32_16x16x32_bf16 v[144:147], a[152:155], a[168:171], v[144:147]
ds_read_b128 a[176:179], v132 offset:12288
v_fmac_f32 v14, v155, v91
v_mfma_f32_16x16x32_bf16 v[144:147], a[156:159], a[172:175], v[144:147]
ds_read_b128 a[180:183], v133 offset:12288
v_lshl_add_u32 v162, v162, 8, v130
v_mfma_f32_16x16x32_bf16 v[148:151], a[160:163], a[160:163], 0
buffer_load_dwordx4 v162, s[8:11], 0 offen offset:2048 lds
v_fmac_f32 v1, v156, v92
v_mfma_f32_16x16x32_bf16 v[148:151], a[164:167], a[164:167], v[148:151]
ds_read_b128 a[184:187], v134 offset:12288
v_fmac_f32 v2, v157, v93
v_mfma_f32_16x16x32_bf16 v[148:151], a[168:171], a[168:171], v[148:151]
ds_read_b128 a[188:191], v135 offset:12288
v_fmac_f32 v13, v158, v94
v_mfma_f32_16x16x32_bf16 v[148:151], a[172:175], a[172:175], v[148:151]
v_fmac_f32 v14, v159, v95
v_lshl_add_u32 v163, v163, 8, v131
s_waitcnt lgkmcnt(0)
v_mfma_f32_16x16x32_bf16 v[152:155], a[112:115], a[176:179], 0
buffer_load_dwordx4 v163, s[8:11], 0 offen offset:3072 lds
v_fmac_f32 v1, v144, v96
v_mfma_f32_16x16x32_bf16 v[152:155], a[116:119], a[180:183], v[152:155]
v_fmac_f32 v2, v145, v97
v_mfma_f32_16x16x32_bf16 v[152:155], a[120:123], a[184:187], v[152:155]
s_add_u32 m0, s51, 8192
v_fmac_f32 v13, v146, v98
v_lshl_add_u32 v164, v164, 8, v128
v_mfma_f32_16x16x32_bf16 v[152:155], a[124:127], a[188:191], v[152:155]
buffer_load_dwordx4 v164, s[8:11], 0 offen offset:0 lds
v_fmac_f32 v14, v147, v99
v_mfma_f32_16x16x32_bf16 v[156:159], a[128:131], a[176:179], 0
v_fmac_f32 v1, v148, v100
v_lshl_add_u32 v165, v165, 8, v129
v_mfma_f32_16x16x32_bf16 v[156:159], a[132:135], a[180:183], v[156:159]
buffer_load_dwordx4 v165, s[8:11], 0 offen offset:1024 lds
v_fmac_f32 v2, v149, v101
v_mfma_f32_16x16x32_bf16 v[156:159], a[136:139], a[184:187], v[156:159]
v_fmac_f32 v13, v150, v102
v_fmac_f32 v14, v151, v103
v_mfma_f32_16x16x32_bf16 v[156:159], a[140:143], a[188:191], v[156:159]
v_mfma_f32_16x16x32_bf16 v[144:147], a[144:147], a[176:179], 0
v_fmac_f32 v1, v152, v104
v_lshl_add_u32 v166, v166, 8, v130
v_mfma_f32_16x16x32_bf16 v[144:147], a[148:151], a[180:183], v[144:147]
buffer_load_dwordx4 v166, s[8:11], 0 offen offset:2048 lds
v_fmac_f32 v2, v153, v105
v_mfma_f32_16x16x32_bf16 v[144:147], a[152:155], a[184:187], v[144:147]
s_waitcnt vmcnt(10)
v_fmac_f32 v13, v154, v106
v_fmac_f32 v14, v155, v107
v_mfma_f32_16x16x32_bf16 v[144:147], a[156:159], a[188:191], v[144:147]
ds_read_b128 a[192:195], v136 offset:4096
v_mfma_f32_16x16x32_bf16 v[148:151], a[160:163], a[176:179], 0
ds_read_b128 a[196:199], v137 offset:4096
v_fmac_f32 v1, v156, v108
v_mfma_f32_16x16x32_bf16 v[148:151], a[164:167], a[180:183], v[148:151]
v_fmac_f32 v2, v157, v109
v_lshl_add_u32 v167, v167, 8, v131
v_mfma_f32_16x16x32_bf16 v[148:151], a[168:171], a[184:187], v[148:151]
buffer_load_dwordx4 v167, s[8:11], 0 offen offset:3072 lds
v_fmac_f32 v13, v158, v110
v_mfma_f32_16x16x32_bf16 v[148:151], a[172:175], a[188:191], v[148:151]
ds_read_b128 a[200:203], v138 offset:4096
v_fmac_f32 v14, v159, v111
v_mfma_f32_16x16x32_bf16 v[152:155], a[176:179], a[176:179], 0
ds_read_b128 a[204:207], v139 offset:4096
v_fmac_f32 v1, v144, v112
v_mfma_f32_16x16x32_bf16 v[152:155], a[180:183], a[180:183], v[152:155]
v_fmac_f32 v2, v145, v113
v_mfma_f32_16x16x32_bf16 v[152:155], a[184:187], a[184:187], v[152:155]
s_add_u32 m0, s51, 0
v_fmac_f32 v13, v146, v114
v_lshl_add_u32 v168, v168, 8, v128
v_mfma_f32_16x16x32_bf16 v[152:155], a[188:191], a[188:191], v[152:155]
buffer_load_dwordx4 v168, s[8:11], 0 offen offset:0 lds
v_fmac_f32 v14, v147, v115
s_waitcnt lgkmcnt(0)
v_mfma_f32_16x16x32_bf16 v[156:159], a[112:115], a[192:195], 0
v_fmac_f32 v1, v148, v116
v_lshl_add_u32 v169, v169, 8, v129
v_mfma_f32_16x16x32_bf16 v[156:159], a[116:119], a[196:199], v[156:159]
buffer_load_dwordx4 v169, s[8:11], 0 offen offset:1024 lds
v_fmac_f32 v2, v149, v117
v_mfma_f32_16x16x32_bf16 v[156:159], a[120:123], a[200:203], v[156:159]
s_waitcnt vmcnt(11)
v_fmac_f32 v13, v150, v118
v_fmac_f32 v14, v151, v119
v_mfma_f32_16x16x32_bf16 v[156:159], a[124:127], a[204:207], v[156:159]
ds_read_b128 a[208:211], v140 offset:8192
v_mfma_f32_16x16x32_bf16 v[144:147], a[128:131], a[192:195], 0
ds_read_b128 a[212:215], v141 offset:8192
v_fmac_f32 v1, v152, v120
v_mfma_f32_16x16x32_bf16 v[144:147], a[132:135], a[196:199], v[144:147]
v_fmac_f32 v2, v153, v121
v_lshl_add_u32 v170, v170, 8, v130
v_mfma_f32_16x16x32_bf16 v[144:147], a[136:139], a[200:203], v[144:147]
buffer_load_dwordx4 v170, s[8:11], 0 offen offset:2048 lds
v_fmac_f32 v13, v154, v122
v_mfma_f32_16x16x32_bf16 v[144:147], a[140:143], a[204:207], v[144:147]
ds_read_b128 a[216:219], v142 offset:8192
v_fmac_f32 v14, v155, v123
v_mfma_f32_16x16x32_bf16 v[148:151], a[144:147], a[192:195], 0
ds_read_b128 a[220:223], v143 offset:8192
v_fmac_f32 v1, v156, v124
v_mfma_f32_16x16x32_bf16 v[148:151], a[148:151], a[196:199], v[148:151]
v_fmac_f32 v2, v157, v125
v_lshl_add_u32 v171, v171, 8, v131
v_mfma_f32_16x16x32_bf16 v[148:151], a[152:155], a[200:203], v[148:151]
buffer_load_dwordx4 v171, s[8:11], 0 offen offset:3072 lds
v_fmac_f32 v13, v158, v126
v_mfma_f32_16x16x32_bf16 v[148:151], a[156:159], a[204:207], v[148:151]
v_fmac_f32 v14, v159, v127
v_mfma_f32_16x16x32_bf16 v[152:155], a[160:163], a[192:195], 0
v_fmac_f32 v1, v144, v16
v_mfma_f32_16x16x32_bf16 v[152:155], a[164:167], a[196:199], v[152:155]
s_add_u32 m0, s51, 4096
v_fmac_f32 v2, v145, v17
v_lshl_add_u32 v172, v172, 8, v128
v_mfma_f32_16x16x32_bf16 v[152:155], a[168:171], a[200:203], v[152:155]
buffer_load_dwordx4 v172, s[8:11], 0 offen offset:0 lds
v_fmac_f32 v13, v146, v18
v_mfma_f32_16x16x32_bf16 v[152:155], a[172:175], a[204:207], v[152:155]
v_fmac_f32 v14, v147, v19
v_mfma_f32_16x16x32_bf16 v[156:159], a[176:179], a[192:195], 0
v_fmac_f32 v1, v148, v20
v_lshl_add_u32 v173, v173, 8, v129
v_mfma_f32_16x16x32_bf16 v[156:159], a[180:183], a[196:199], v[156:159]
buffer_load_dwordx4 v173, s[8:11], 0 offen offset:1024 lds
v_fmac_f32 v2, v149, v21
v_mfma_f32_16x16x32_bf16 v[156:159], a[184:187], a[200:203], v[156:159]
s_waitcnt vmcnt(10)
v_fmac_f32 v13, v150, v22
v_fmac_f32 v14, v151, v23
v_mfma_f32_16x16x32_bf16 v[156:159], a[188:191], a[204:207], v[156:159]
ds_read_b128 a[0:3], v136 offset:12288
v_mfma_f32_16x16x32_bf16 v[144:147], a[192:195], a[192:195], 0
ds_read_b128 a[4:7], v137 offset:12288
v_fmac_f32 v1, v152, v24
v_mfma_f32_16x16x32_bf16 v[144:147], a[196:199], a[196:199], v[144:147]
v_fmac_f32 v2, v153, v25
v_lshl_add_u32 v174, v174, 8, v130
v_mfma_f32_16x16x32_bf16 v[144:147], a[200:203], a[200:203], v[144:147]
buffer_load_dwordx4 v174, s[8:11], 0 offen offset:2048 lds
v_fmac_f32 v13, v154, v26
v_mfma_f32_16x16x32_bf16 v[144:147], a[204:207], a[204:207], v[144:147]
ds_read_b128 a[8:11], v138 offset:12288
v_fmac_f32 v14, v155, v27
s_waitcnt lgkmcnt(3)
v_mfma_f32_16x16x32_bf16 v[148:151], a[112:115], a[208:211], 0
ds_read_b128 a[12:15], v139 offset:12288
v_fmac_f32 v1, v156, v28
v_mfma_f32_16x16x32_bf16 v[148:151], a[116:119], a[212:215], v[148:151]
v_fmac_f32 v2, v157, v29
v_lshl_add_u32 v175, v175, 8, v131
v_mfma_f32_16x16x32_bf16 v[148:151], a[120:123], a[216:219], v[148:151]
buffer_load_dwordx4 v175, s[8:11], 0 offen offset:3072 lds
v_fmac_f32 v13, v158, v30
v_mfma_f32_16x16x32_bf16 v[148:151], a[124:127], a[220:223], v[148:151]
v_fmac_f32 v14, v159, v31
v_mfma_f32_16x16x32_bf16 v[152:155], a[128:131], a[208:211], 0
v_fmac_f32 v1, v144, v32
v_mfma_f32_16x16x32_bf16 v[152:155], a[132:135], a[212:215], v[152:155]
s_add_u32 m0, s57, 12288
v_fmac_f32 v2, v145, v33
v_lshl_add_u32 v176, v176, 8, v128
v_mfma_f32_16x16x32_bf16 v[152:155], a[136:139], a[216:219], v[152:155]
buffer_load_dwordx4 v176, s[8:11], 0 offen offset:0 lds
v_fmac_f32 v13, v146, v34
v_mfma_f32_16x16x32_bf16 v[152:155], a[140:143], a[220:223], v[152:155]
v_fmac_f32 v14, v147, v35
v_mfma_f32_16x16x32_bf16 v[156:159], a[144:147], a[208:211], 0
v_fmac_f32 v1, v148, v36
v_lshl_add_u32 v177, v177, 8, v129
v_mfma_f32_16x16x32_bf16 v[156:159], a[148:151], a[212:215], v[156:159]
buffer_load_dwordx4 v177, s[8:11], 0 offen offset:1024 lds
v_fmac_f32 v2, v149, v37
v_mfma_f32_16x16x32_bf16 v[156:159], a[152:155], a[216:219], v[156:159]
s_waitcnt vmcnt(10)
v_fmac_f32 v13, v150, v38
v_fmac_f32 v14, v151, v39
v_mfma_f32_16x16x32_bf16 v[156:159], a[156:159], a[220:223], v[156:159]
ds_read_b128 a[16:19], v136 offset:8192
v_mfma_f32_16x16x32_bf16 v[144:147], a[160:163], a[208:211], 0
ds_read_b128 a[20:23], v137 offset:8192
v_fmac_f32 v1, v152, v40
v_mfma_f32_16x16x32_bf16 v[144:147], a[164:167], a[212:215], v[144:147]
v_fmac_f32 v2, v153, v41
v_lshl_add_u32 v178, v178, 8, v130
v_mfma_f32_16x16x32_bf16 v[144:147], a[168:171], a[216:219], v[144:147]
buffer_load_dwordx4 v178, s[8:11], 0 offen offset:2048 lds
v_fmac_f32 v13, v154, v42
v_mfma_f32_16x16x32_bf16 v[144:147], a[172:175], a[220:223], v[144:147]
ds_read_b128 a[24:27], v138 offset:8192
v_fmac_f32 v14, v155, v43
v_mfma_f32_16x16x32_bf16 v[148:151], a[176:179], a[208:211], 0
ds_read_b128 a[28:31], v139 offset:8192
v_fmac_f32 v1, v156, v44
v_mfma_f32_16x16x32_bf16 v[148:151], a[180:183], a[212:215], v[148:151]
v_fmac_f32 v2, v157, v45
v_lshl_add_u32 v179, v179, 8, v131
v_mfma_f32_16x16x32_bf16 v[148:151], a[184:187], a[216:219], v[148:151]
buffer_load_dwordx4 v179, s[8:11], 0 offen offset:3072 lds
v_fmac_f32 v13, v158, v46
v_mfma_f32_16x16x32_bf16 v[148:151], a[188:191], a[220:223], v[148:151]
v_fmac_f32 v14, v159, v47
v_mfma_f32_16x16x32_bf16 v[152:155], a[192:195], a[208:211], 0
s_waitcnt lgkmcnt(4)
v_fmac_f32 v1, v144, v48
v_mfma_f32_16x16x32_bf16 v[152:155], a[196:199], a[212:215], v[152:155]
s_add_u32 m0, s51, 12288
v_fmac_f32 v2, v145, v49
v_lshl_add_u32 v180, v180, 8, v128
v_mfma_f32_16x16x32_bf16 v[152:155], a[200:203], a[216:219], v[152:155]
buffer_load_dwordx4 v180, s[8:11], 0 offen offset:0 lds
v_fmac_f32 v13, v146, v50
v_mfma_f32_16x16x32_bf16 v[152:155], a[204:207], a[220:223], v[152:155]
v_fmac_f32 v14, v147, v51
v_mfma_f32_16x16x32_bf16 v[156:159], a[208:211], a[208:211], 0
v_fmac_f32 v1, v148, v52
v_lshl_add_u32 v181, v181, 8, v129
v_mfma_f32_16x16x32_bf16 v[156:159], a[212:215], a[212:215], v[156:159]
buffer_load_dwordx4 v181, s[8:11], 0 offen offset:1024 lds
v_fmac_f32 v2, v149, v53
v_mfma_f32_16x16x32_bf16 v[156:159], a[216:219], a[216:219], v[156:159]
s_waitcnt vmcnt(10)
v_fmac_f32 v13, v150, v54
v_fmac_f32 v14, v151, v55
v_mfma_f32_16x16x32_bf16 v[156:159], a[220:223], a[220:223], v[156:159]
ds_read_b128 a[32:35], v136 offset:0
v_mfma_f32_16x16x32_bf16 v[144:147], a[0:3], a[0:3], 0
ds_read_b128 a[36:39], v137 offset:0
v_fmac_f32 v1, v152, v56
v_mfma_f32_16x16x32_bf16 v[144:147], a[4:7], a[4:7], v[144:147]
v_fmac_f32 v2, v153, v57
v_lshl_add_u32 v182, v182, 8, v130
v_mfma_f32_16x16x32_bf16 v[144:147], a[8:11], a[8:11], v[144:147]
buffer_load_dwordx4 v182, s[8:11], 0 offen offset:2048 lds
v_fmac_f32 v13, v154, v58
v_mfma_f32_16x16x32_bf16 v[144:147], a[12:15], a[12:15], v[144:147]
ds_read_b128 a[40:43], v138 offset:0
v_fmac_f32 v14, v155, v59
s_waitcnt lgkmcnt(3)
v_mfma_f32_16x16x32_bf16 v[148:151], a[0:3], a[16:19], 0
ds_read_b128 a[44:47], v139 offset:0
v_fmac_f32 v1, v156, v60
v_fmac_f32 v2, v157, v61
v_mfma_f32_16x16x32_bf16 v[148:151], a[4:7], a[20:23], v[148:151]
v_fmac_f32 v13, v158, v62
v_fmac_f32 v14, v159, v63
v_mfma_f32_16x16x32_bf16 v[148:151], a[8:11], a[24:27], v[148:151]
v_add_f32 v1, v1, v2
v_add_f32 v13, v13, v14
v_mfma_f32_16x16x32_bf16 v[148:151], a[12:15], a[28:31], v[148:151]
v_add_f32 v1, v1, v13
v_accvgpr_write_b32 a253, v1
v_mfma_f32_16x16x32_bf16 v[152:155], a[16:19], a[16:19], 0
v_mul_f32 v1, v144, v64
v_lshl_add_u32 v183, v183, 8, v131
v_mfma_f32_16x16x32_bf16 v[152:155], a[20:23], a[20:23], v[152:155]
buffer_load_dwordx4 v183, s[8:11], 0 offen offset:3072 lds
v_mul_f32 v2, v145, v65
v_mfma_f32_16x16x32_bf16 v[152:155], a[24:27], a[24:27], v[152:155]
v_mul_f32 v13, v146, v66
v_mfma_f32_16x16x32_bf16 v[152:155], a[28:31], a[28:31], v[152:155]
s_add_u32 m0, s57, 8192
v_mul_f32 v14, v147, v67
v_lshl_add_u32 v184, v184, 8, v128
s_waitcnt lgkmcnt(0)
v_mfma_f32_16x16x32_bf16 v[156:159], a[0:3], a[32:35], 0
buffer_load_dwordx4 v184, s[8:11], 0 offen offset:0 lds
v_fmac_f32 v1, v148, v68
v_mfma_f32_16x16x32_bf16 v[156:159], a[4:7], a[36:39], v[156:159]
v_fmac_f32 v2, v149, v69
v_mfma_f32_16x16x32_bf16 v[156:159], a[8:11], a[40:43], v[156:159]
s_add_u32 m0, s51, 8192
v_fmac_f32 v13, v150, v70
v_lshl_add_u32 v188, v188, 8, v128
v_mfma_f32_16x16x32_bf16 v[156:159], a[12:15], a[44:47], v[156:159]
buffer_load_dwordx4 v188, s[8:11], 0 offen offset:0 lds
v_fmac_f32 v14, v151, v71
v_mfma_f32_16x16x32_bf16 v[144:147], a[16:19], a[32:35], 0
s_waitcnt vmcnt(10)
v_fmac_f32 v1, v152, v72
v_fmac_f32 v2, v153, v73
v_mfma_f32_16x16x32_bf16 v[144:147], a[20:23], a[36:39], v[144:147]
ds_read_b128 a[48:51], v136 offset:4096
v_fmac_f32 v13, v154, v74
v_mfma_f32_16x16x32_bf16 v[144:147], a[24:27], a[40:43], v[144:147]
ds_read_b128 a[52:55], v137 offset:4096
v_fmac_f32 v14, v155, v75
v_mfma_f32_16x16x32_bf16 v[144:147], a[28:31], a[44:47], v[144:147]
v_lshl_add_u32 v189, v189, 8, v129
v_mfma_f32_16x16x32_bf16 v[148:151], a[32:35], a[32:35], 0
buffer_load_dwordx4 v189, s[8:11], 0 offen offset:1024 lds
v_fmac_f32 v1, v156, v76
v_mfma_f32_16x16x32_bf16 v[148:151], a[36:39], a[36:39], v[148:151]
ds_read_b128 a[56:59], v138 offset:4096
v_fmac_f32 v2, v157, v77
v_mfma_f32_16x16x32_bf16 v[148:151], a[40:43], a[40:43], v[148:151]
ds_read_b128 a[60:63], v139 offset:4096
v_fmac_f32 v13, v158, v78
v_mfma_f32_16x16x32_bf16 v[148:151], a[44:47], a[44:47], v[148:151]
v_fmac_f32 v14, v159, v79
v_lshl_add_u32 v190, v190, 8, v130
s_waitcnt lgkmcnt(0)
v_mfma_f32_16x16x32_bf16 v[152:155], a[0:3], a[48:51], 0
buffer_load_dwordx4 v190, s[8:11], 0 offen offset:2048 lds
v_fmac_f32 v1, v144, v80
v_mfma_f32_16x16x32_bf16 v[152:155], a[4:7], a[52:55], v[152:155]
v_fmac_f32 v2, v145, v81
v_lshl_add_u32 v191, v191, 8, v131
v_mfma_f32_16x16x32_bf16 v[152:155], a[8:11], a[56:59], v[152:155]
buffer_load_dwordx4 v191, s[8:11], 0 offen offset:3072 lds
v_fmac_f32 v13, v146, v82
v_mfma_f32_16x16x32_bf16 v[152:155], a[12:15], a[60:63], v[152:155]
v_fmac_f32 v14, v147, v83
v_mfma_f32_16x16x32_bf16 v[156:159], a[16:19], a[48:51], 0
v_fmac_f32 v1, v148, v84
v_mfma_f32_16x16x32_bf16 v[156:159], a[20:23], a[52:55], v[156:159]
s_add_u32 m0, s51, 4096
v_fmac_f32 v2, v149, v85
v_lshl_add_u32 v192, v192, 8, v128
v_mfma_f32_16x16x32_bf16 v[156:159], a[24:27], a[56:59], v[156:159]
buffer_load_dwordx4 v192, s[8:11], 0 offen offset:0 lds
v_fmac_f32 v13, v150, v86
v_mfma_f32_16x16x32_bf16 v[156:159], a[28:31], a[60:63], v[156:159]
s_waitcnt vmcnt(10)
v_fmac_f32 v14, v151, v87
v_mfma_f32_16x16x32_bf16 v[144:147], a[32:35], a[48:51], 0
ds_read_b128 a[64:67], v132 offset:12288
v_fmac_f32 v1, v152, v88
v_mfma_f32_16x16x32_bf16 v[144:147], a[36:39], a[52:55], v[144:147]
ds_read_b128 a[68:71], v133 offset:12288
v_fmac_f32 v2, v153, v89
v_mfma_f32_16x16x32_bf16 v[144:147], a[40:43], a[56:59], v[144:147]
v_fmac_f32 v13, v154, v90
v_lshl_add_u32 v193, v193, 8, v129
v_mfma_f32_16x16x32_bf16 v[144:147], a[44:47], a[60:63], v[144:147]
buffer_load_dwordx4 v193, s[8:11], 0 offen offset:1024 lds
v_fmac_f32 v14, v155, v91
v_mfma_f32_16x16x32_bf16 v[148:151], a[48:51], a[48:51], 0
ds_read_b128 a[72:75], v134 offset:12288
v_fmac_f32 v1, v156, v92
v_mfma_f32_16x16x32_bf16 v[148:151], a[52:55], a[52:55], v[148:151]
ds_read_b128 a[76:79], v135 offset:12288
v_fmac_f32 v2, v157, v93
v_mfma_f32_16x16x32_bf16 v[148:151], a[56:59], a[56:59], v[148:151]
v_fmac_f32 v13, v158, v94
v_lshl_add_u32 v194, v194, 8, v130
v_mfma_f32_16x16x32_bf16 v[148:151], a[60:63], a[60:63], v[148:151]
buffer_load_dwordx4 v194, s[8:11], 0 offen offset:2048 lds
v_fmac_f32 v14, v159, v95
s_waitcnt lgkmcnt(0)
v_mfma_f32_16x16x32_bf16 v[152:155], a[0:3], a[64:67], 0
v_fmac_f32 v1, v144, v96
v_lshl_add_u32 v195, v195, 8, v131
v_mfma_f32_16x16x32_bf16 v[152:155], a[4:7], a[68:71], v[152:155]
buffer_load_dwordx4 v195, s[8:11], 0 offen offset:3072 lds
v_fmac_f32 v2, v145, v97
v_mfma_f32_16x16x32_bf16 v[152:155], a[8:11], a[72:75], v[152:155]
v_fmac_f32 v13, v146, v98
v_fmac_f32 v14, v147, v99
v_mfma_f32_16x16x32_bf16 v[152:155], a[12:15], a[76:79], v[152:155]
v_mfma_f32_16x16x32_bf16 v[156:159], a[16:19], a[64:67], 0
v_fmac_f32 v1, v148, v100
v_mfma_f32_16x16x32_bf16 v[156:159], a[20:23], a[68:71], v[156:159]
s_add_u32 m0, s51, 0
v_fmac_f32 v2, v149, v101
v_lshl_add_u32 v196, v196, 8, v128
v_mfma_f32_16x16x32_bf16 v[156:159], a[24:27], a[72:75], v[156:159]
buffer_load_dwordx4 v196, s[8:11], 0 offen offset:0 lds
v_fmac_f32 v13, v150, v102
v_mfma_f32_16x16x32_bf16 v[156:159], a[28:31], a[76:79], v[156:159]
s_waitcnt vmcnt(10)
v_fmac_f32 v14, v151, v103
v_mfma_f32_16x16x32_bf16 v[144:147], a[32:35], a[64:67], 0
ds_read_b128 a[80:83], v136 offset:12288
v_fmac_f32 v1, v152, v104
v_mfma_f32_16x16x32_bf16 v[144:147], a[36:39], a[68:71], v[144:147]
ds_read_b128 a[84:87], v137 offset:12288
v_fmac_f32 v2, v153, v105
v_mfma_f32_16x16x32_bf16 v[144:147], a[40:43], a[72:75], v[144:147]
v_fmac_f32 v13, v154, v106
v_lshl_add_u32 v197, v197, 8, v129
v_mfma_f32_16x16x32_bf16 v[144:147], a[44:47], a[76:79], v[144:147]
buffer_load_dwordx4 v197, s[8:11], 0 offen offset:1024 lds
v_fmac_f32 v14, v155, v107
v_mfma_f32_16x16x32_bf16 v[148:151], a[48:51], a[64:67], 0
ds_read_b128 a[88:91], v138 offset:12288
v_fmac_f32 v1, v156, v108
v_mfma_f32_16x16x32_bf16 v[148:151], a[52:55], a[68:71], v[148:151]
ds_read_b128 a[92:95], v139 offset:12288
v_fmac_f32 v2, v157, v109
v_mfma_f32_16x16x32_bf16 v[148:151], a[56:59], a[72:75], v[148:151]
v_fmac_f32 v13, v158, v110
v_lshl_add_u32 v198, v198, 8, v130
v_mfma_f32_16x16x32_bf16 v[148:151], a[60:63], a[76:79], v[148:151]
buffer_load_dwordx4 v198, s[8:11], 0 offen offset:2048 lds
v_fmac_f32 v14, v159, v111
v_mfma_f32_16x16x32_bf16 v[152:155], a[64:67], a[64:67], 0
s_waitcnt vmcnt(11)
v_fmac_f32 v1, v144, v112
v_fmac_f32 v2, v145, v113
v_mfma_f32_16x16x32_bf16 v[152:155], a[68:71], a[68:71], v[152:155]
ds_read_b128 a[96:99], v140 offset:8192
v_fmac_f32 v13, v146, v114
v_mfma_f32_16x16x32_bf16 v[152:155], a[72:75], a[72:75], v[152:155]
ds_read_b128 a[100:103], v141 offset:8192
v_fmac_f32 v14, v147, v115
v_mfma_f32_16x16x32_bf16 v[152:155], a[76:79], a[76:79], v[152:155]
v_lshl_add_u32 v199, v199, 8, v131
s_waitcnt lgkmcnt(2)
v_mfma_f32_16x16x32_bf16 v[156:159], a[0:3], a[80:83], 0
buffer_load_dwordx4 v199, s[8:11], 0 offen offset:3072 lds
v_fmac_f32 v1, v148, v116
v_mfma_f32_16x16x32_bf16 v[156:159], a[4:7], a[84:87], v[156:159]
ds_read_b128 a[104:107], v142 offset:8192
v_fmac_f32 v2, v149, v117
v_mfma_f32_16x16x32_bf16 v[156:159], a[8:11], a[88:91], v[156:159]
ds_read_b128 a[108:111], v143 offset:8192
v_fmac_f32 v13, v150, v118
v_mfma_f32_16x16x32_bf16 v[156:159], a[12:15], a[92:95], v[156:159]
v_fmac_f32 v14, v151, v119
v_mfma_f32_16x16x32_bf16 v[144:147], a[16:19], a[80:83], 0
s_add_u32 m0, s51, 12288
v_fmac_f32 v1, v152, v120
v_lshl_add_u32 v200, v200, 8, v128
v_mfma_f32_16x16x32_bf16 v[144:147], a[20:23], a[84:87], v[144:147]
buffer_load_dwordx4 v200, s[8:11], 0 offen offset:0 lds
v_fmac_f32 v2, v153, v121
v_mfma_f32_16x16x32_bf16 v[144:147], a[24:27], a[88:91], v[144:147]
v_fmac_f32 v13, v154, v122
v_lshl_add_u32 v201, v201, 8, v129
v_mfma_f32_16x16x32_bf16 v[144:147], a[28:31], a[92:95], v[144:147]
buffer_load_dwordx4 v201, s[8:11], 0 offen offset:1024 lds
v_fmac_f32 v14, v155, v123
v_mfma_f32_16x16x32_bf16 v[148:151], a[32:35], a[80:83], 0
s_waitcnt vmcnt(10)
v_fmac_f32 v1, v156, v124
v_fmac_f32 v2, v157, v125
v_mfma_f32_16x16x32_bf16 v[148:151], a[36:39], a[84:87], v[148:151]
ds_read_b128 a[112:115], v136 offset:8192
v_fmac_f32 v13, v158, v126
v_mfma_f32_16x16x32_bf16 v[148:151], a[40:43], a[88:91], v[148:151]
ds_read_b128 a[116:119], v137 offset:8192
v_fmac_f32 v14, v159, v127
v_mfma_f32_16x16x32_bf16 v[148:151], a[44:47], a[92:95], v[148:151]
v_lshl_add_u32 v202, v202, 8, v130
v_mfma_f32_16x16x32_bf16 v[152:155], a[48:51], a[80:83], 0
buffer_load_dwordx4 v202, s[8:11], 0 offen offset:2048 lds
v_fmac_f32 v1, v144, v16
v_mfma_f32_16x16x32_bf16 v[152:155], a[52:55], a[84:87], v[152:155]
ds_read_b128 a[120:123], v138 offset:8192
v_fmac_f32 v2, v145, v17
v_mfma_f32_16x16x32_bf16 v[152:155], a[56:59], a[88:91], v[152:155]
ds_read_b128 a[124:127], v139 offset:8192
v_fmac_f32 v13, v146, v18
v_mfma_f32_16x16x32_bf16 v[152:155], a[60:63], a[92:95], v[152:155]
v_fmac_f32 v14, v147, v19
v_lshl_add_u32 v203, v203, 8, v131
v_mfma_f32_16x16x32_bf16 v[156:159], a[64:67], a[80:83], 0
buffer_load_dwordx4 v203, s[8:11], 0 offen offset:3072 lds
v_fmac_f32 v1, v148, v20
s_cmp_lg_u32 s3, 1
s_cbranch_scc1 L_p2i
v_lshlrev_b32 v233, 2, v7
buffer_load_dword v220, v5, s[12:15], 0 offen offset:0 sc1
buffer_load_dword v221, v5, s[12:15], 0 offen offset:1024 sc1
buffer_load_dword v222, v5, s[12:15], 0 offen offset:2048 sc1
buffer_load_dword v223, v5, s[12:15], 0 offen offset:3072 sc1
buffer_load_dword v232, v233, s[24:27], 0 offen offset:32 sc1
L_p2i:
v_mfma_f32_16x16x32_bf16 v[156:159], a[68:71], a[84:87], v[156:159]
v_fmac_f32 v2, v149, v21
v_mfma_f32_16x16x32_bf16 v[156:159], a[72:75], a[88:91], v[156:159]
s_add_u32 m0, s57, 12288
v_fmac_f32 v13, v150, v22
v_lshl_add_u32 v204, v204, 8, v128
v_mfma_f32_16x16x32_bf16 v[156:159], a[76:79], a[92:95], v[156:159]
buffer_load_dwordx4 v204, s[8:11], 0 offen offset:0 lds
v_fmac_f32 v14, v151, v23
v_mfma_f32_16x16x32_bf16 v[144:147], a[80:83], a[80:83], 0
v_fmac_f32 v1, v152, v24
v_lshl_add_u32 v205, v205, 8, v129
v_mfma_f32_16x16x32_bf16 v[144:147], a[84:87], a[84:87], v[144:147]
buffer_load_dwordx4 v205, s[8:11], 0 offen offset:1024 lds
v_fmac_f32 v2, v153, v25
v_mfma_f32_16x16x32_bf16 v[144:147], a[88:91], a[88:91], v[144:147]
s_waitcnt vmcnt(10)
v_fmac_f32 v13, v154, v26
v_fmac_f32 v14, v155, v27
v_mfma_f32_16x16x32_bf16 v[144:147], a[92:95], a[92:95], v[144:147]
ds_read_b128 a[128:131], v136 offset:4096
s_waitcnt lgkmcnt(5)
v_mfma_f32_16x16x32_bf16 v[148:151], a[0:3], a[96:99], 0
ds_read_b128 a[132:135], v137 offset:4096
v_fmac_f32 v1, v156, v28
v_mfma_f32_16x16x32_bf16 v[148:151], a[4:7], a[100:103], v[148:151]
v_fmac_f32 v2, v157, v29
v_lshl_add_u32 v206, v206, 8, v130
v_mfma_f32_16x16x32_bf16 v[148:151], a[8:11], a[104:107], v[148:151]
buffer_load_dwordx4 v206, s[8:11], 0 offen offset:2048 lds
v_fmac_f32 v13, v158, v30
v_mfma_f32_16x16x32_bf16 v[148:151], a[12:15], a[108:111], v[148:151]
ds_read_b128 a[136:139], v138 offset:4096
v_fmac_f32 v14, v159, v31
v_mfma_f32_16x16x32_bf16 v[152:155], a[16:19], a[96:99], 0
ds_read_b128 a[140:143], v139 offset:4096
v_fmac_f32 v1, v144, v32
v_mfma_f32_16x16x32_bf16 v[152:155], a[20:23], a[100:103], v[152:155]
v_fmac_f32 v2, v145, v33
v_lshl_add_u32 v207, v207, 8, v131
v_mfma_f32_16x16x32_bf16 v[152:155], a[24:27], a[104:107], v[152:155]
buffer_load_dwordx4 v207, s[8:11], 0 offen offset:3072 lds
v_fmac_f32 v13, v146, v34
v_mfma_f32_16x16x32_bf16 v[152:155], a[28:31], a[108:111], v[152:155]
v_fmac_f32 v14, v147, v35
v_mfma_f32_16x16x32_bf16 v[156:159], a[32:35], a[96:99], 0
s_waitcnt lgkmcnt(4)
v_fmac_f32 v1, v148, v36
v_mfma_f32_16x16x32_bf16 v[156:159], a[36:39], a[100:103], v[156:159]
s_add_u32 m0, s51, 8192
v_fmac_f32 v2, v149, v37
v_lshl_add_u32 v208, v208, 8, v128
v_mfma_f32_16x16x32_bf16 v[156:159], a[40:43], a[104:107], v[156:159]
buffer_load_dwordx4 v208, s[8:11], 0 offen offset:0 lds
v_fmac_f32 v13, v150, v38
v_mfma_f32_16x16x32_bf16 v[156:159], a[44:47], a[108:111], v[156:159]
v_fmac_f32 v14, v151, v39
v_mfma_f32_16x16x32_bf16 v[144:147], a[48:51], a[96:99], 0
v_fmac_f32 v1, v152, v40
v_lshl_add_u32 v209, v209, 8, v129
v_mfma_f32_16x16x32_bf16 v[144:147], a[52:55], a[100:103], v[144:147]
buffer_load_dwordx4 v209, s[8:11], 0 offen offset:1024 lds
v_fmac_f32 v2, v153, v41
v_mfma_f32_16x16x32_bf16 v[144:147], a[56:59], a[104:107], v[144:147]
s_waitcnt vmcnt(10)
v_fmac_f32 v13, v154, v42
v_fmac_f32 v14, v155, v43
v_mfma_f32_16x16x32_bf16 v[144:147], a[60:63], a[108:111], v[144:147]
ds_read_b128 a[144:147], v136 offset:0
v_mfma_f32_16x16x32_bf16 v[148:151], a[64:67], a[96:99], 0
ds_read_b128 a[148:151], v137 offset:0
v_fmac_f32 v1, v156, v44
v_mfma_f32_16x16x32_bf16 v[148:151], a[68:71], a[100:103], v[148:151]
v_fmac_f32 v2, v157, v45
v_lshl_add_u32 v210, v210, 8, v130
v_mfma_f32_16x16x32_bf16 v[148:151], a[72:75], a[104:107], v[148:151]
buffer_load_dwordx4 v210, s[8:11], 0 offen offset:2048 lds
v_fmac_f32 v13, v158, v46
v_mfma_f32_16x16x32_bf16 v[148:151], a[76:79], a[108:111], v[148:151]
ds_read_b128 a[152:155], v138 offset:0
v_fmac_f32 v14, v159, v47
v_mfma_f32_16x16x32_bf16 v[152:155], a[80:83], a[96:99], 0
ds_read_b128 a[156:159], v139 offset:0
v_fmac_f32 v1, v144, v48
v_mfma_f32_16x16x32_bf16 v[152:155], a[84:87], a[100:103], v[152:155]
v_fmac_f32 v2, v145, v49
v_lshl_add_u32 v211, v211, 8, v131
v_mfma_f32_16x16x32_bf16 v[152:155], a[88:91], a[104:107], v[152:155]
buffer_load_dwordx4 v211, s[8:11], 0 offen offset:3072 lds
v_fmac_f32 v13, v146, v50
v_mfma_f32_16x16x32_bf16 v[152:155], a[92:95], a[108:111], v[152:155]
v_fmac_f32 v14, v147, v51
v_mfma_f32_16x16x32_bf16 v[156:159], a[96:99], a[96:99], 0
v_fmac_f32 v1, v148, v52
v_mfma_f32_16x16x32_bf16 v[156:159], a[100:103], a[100:103], v[156:159]
s_add_u32 m0, s57, 8192
v_fmac_f32 v2, v149, v53
v_lshl_add_u32 v212, v212, 8, v128
v_mfma_f32_16x16x32_bf16 v[156:159], a[104:107], a[104:107], v[156:159]
buffer_load_dwordx4 v212, s[8:11], 0 offen offset:0 lds
v_fmac_f32 v13, v150, v54
v_mfma_f32_16x16x32_bf16 v[156:159], a[108:111], a[108:111], v[156:159]
v_fmac_f32 v14, v151, v55
v_mfma_f32_16x16x32_bf16 v[144:147], a[112:115], a[112:115], 0
s_waitcnt vmcnt(9)
v_fmac_f32 v1, v152, v56
v_fmac_f32 v2, v153, v57
v_mfma_f32_16x16x32_bf16 v[144:147], a[116:119], a[116:119], v[144:147]
ds_read_b128 a[160:163], v136 offset:12288
v_fmac_f32 v13, v154, v58
v_mfma_f32_16x16x32_bf16 v[144:147], a[120:123], a[120:123], v[144:147]
ds_read_b128 a[164:167], v137 offset:12288
v_fmac_f32 v14, v155, v59
s_cmp_lg_u32 s3, 1
s_cbranch_scc1 L_poll2d
s_mov_b32 s42, 1000
s_mov_b32 s43, 0
L_poll2:
s_waitcnt vmcnt(0)
v_xor_b32 v220, s56, v220
v_xor_b32 v221, s56, v221
v_xor_b32 v222, s56, v222
v_xor_b32 v223, s56, v223
v_or3_b32 v220, v220, v221, v222
v_or_b32 v220, v220, v223
v_cmp_eq_u32 vcc, 0, v220
s_nop 1
s_cmp_eq_u64 vcc, -1
s_cbranch_scc1 L_poll2k
s_sleep 4
buffer_load_dword v220, v5, s[12:15], 0 offen offset:0 sc1
buffer_load_dword v221, v5, s[12:15], 0 offen offset:1024 sc1
buffer_load_dword v222, v5, s[12:15], 0 offen offset:2048 sc1
buffer_load_dword v223, v5, s[12:15], 0 offen offset:3072 sc1
buffer_load_dword v232, v233, s[24:27], 0 offen offset:32 sc1
s_sub_u32 s42, s42, 1
s_cmp_lg_u32 s42, 0
s_cbranch_scc1 L_poll2
s_branch L_fb2
L_poll2k:
v_writelane_b32 v232, s43, 8
v_add_u32 v233, 162816, v233
ds_write_b32 v233, v232
L_poll2d:
s_barrier
s_lshl_b32 s43, s3, 20
s_lshl_b32 s44, s60, 7
s_add_u32 s43, s43, s44
s_mov_b32 s22, 16777216
v_mfma_f32_16x16x32_bf16 v[144:147], a[124:127], a[124:127], v[144:147]
s_waitcnt lgkmcnt(6)
v_mfma_f32_16x16x32_bf16 v[148:151], a[112:115], a[128:131], 0
ds_read_b128 a[168:171], v138 offset:12288
v_fmac_f32 v1, v156, v60
v_fmac_f32 v2, v157, v61
v_mfma_f32_16x16x32_bf16 v[148:151], a[116:119], a[132:135], v[148:151]
ds_read_b128 a[172:175], v139 offset:12288
v_fmac_f32 v13, v158, v62
v_fmac_f32 v14, v159, v63
v_mfma_f32_16x16x32_bf16 v[148:151], a[120:123], a[136:139], v[148:151]
s_add_u32 s52, s43, 0
v_add_f32 v1, v1, v2
v_add_f32 v13, v13, v14
v_mfma_f32_16x16x32_bf16 v[148:151], a[124:127], a[140:143], v[148:151]
buffer_load_dwordx4 v[160:163], v218, s[20:23], s52 offen sc1
v_add_f32 v1, v1, v13
v_accvgpr_write_b32 a254, v1
v_mfma_f32_16x16x32_bf16 v[152:155], a[128:131], a[128:131], 0
s_add_u32 s52, s52, 8388608
v_mul_f32 v1, v144, v64
v_mul_f32 v2, v145, v65
v_mfma_f32_16x16x32_bf16 v[152:155], a[132:135], a[132:135], v[152:155]
buffer_load_dwordx4 v[164:167], v218, s[20:23], s52 offen sc1
v_mul_f32 v13, v146, v66
v_mfma_f32_16x16x32_bf16 v[152:155], a[136:139], a[136:139], v[152:155]
s_add_u32 s52, s43, 32768
v_mul_f32 v14, v147, v67
v_mfma_f32_16x16x32_bf16 v[152:155], a[140:143], a[140:143], v[152:155]
buffer_load_dwordx4 v[168:171], v218, s[20:23], s52 offen sc1
s_add_u32 s52, s52, 8388608
s_waitcnt lgkmcnt(4)
v_mfma_f32_16x16x32_bf16 v[156:159], a[112:115], a[144:147], 0
buffer_load_dwordx4 v[172:175], v218, s[20:23], s52 offen sc1
v_fmac_f32 v1, v148, v68
v_mfma_f32_16x16x32_bf16 v[156:159], a[116:119], a[148:151], v[156:159]
s_add_u32 s52, s43, 65536
v_fmac_f32 v2, v149, v69
v_fmac_f32 v13, v150, v70
v_mfma_f32_16x16x32_bf16 v[156:159], a[120:123], a[152:155], v[156:159]
buffer_load_dwordx4 v[176:179], v218, s[20:23], s52 offen sc1
v_fmac_f32 v14, v151, v71
v_mfma_f32_16x16x32_bf16 v[156:159], a[124:127], a[156:159], v[156:159]
s_add_u32 s52, s52, 8388608
v_mfma_f32_16x16x32_bf16 v[144:147], a[128:131], a[144:147], 0
buffer_load_dwordx4 v[180:183], v218, s[20:23], s52 offen sc1
v_fmac_f32 v1, v152, v72
v_mfma_f32_16x16x32_bf16 v[144:147], a[132:135], a[148:151], v[144:147]
s_waitcnt vmcnt(11)
v_fmac_f32 v2, v153, v73
v_fmac_f32 v13, v154, v74
v_mfma_f32_16x16x32_bf16 v[144:147], a[136:139], a[152:155], v[144:147]
ds_read_b128 a[176:179], v132 offset:12288
v_fmac_f32 v14, v155, v75
v_mfma_f32_16x16x32_bf16 v[144:147], a[140:143], a[156:159], v[144:147]
ds_read_b128 a[180:183], v133 offset:12288
s_add_u32 s52, s43, 98304
v_mfma_f32_16x16x32_bf16 v[148:151], a[144:147], a[144:147], 0
buffer_load_dwordx4 a[224:227], v218, s[20:23], s52 offen sc1
v_fmac_f32 v1, v156, v76
v_mfma_f32_16x16x32_bf16 v[148:151], a[148:151], a[148:151], v[148:151]
s_add_u32 s52, s52, 8388608
v_fmac_f32 v2, v157, v77
v_fmac_f32 v13, v158, v78
v_mfma_f32_16x16x32_bf16 v[148:151], a[152:155], a[152:155], v[148:151]
buffer_load_dwordx4 a[228:231], v218, s[20:23], s52 offen sc1
v_fmac_f32 v14, v159, v79
v_mfma_f32_16x16x32_bf16 v[148:151], a[156:159], a[156:159], v[148:151]
ds_read_b128 a[184:187], v134 offset:12288
s_waitcnt lgkmcnt(3)
v_mfma_f32_16x16x32_bf16 v[152:155], a[112:115], a[160:163], 0
ds_read_b128 a[188:191], v135 offset:12288
v_fmac_f32 v1, v144, v80
v_mfma_f32_16x16x32_bf16 v[152:155], a[116:119], a[164:167], v[152:155]
s_add_u32 s52, s43, 131072
v_fmac_f32 v2, v145, v81
v_fmac_f32 v13, v146, v82
v_mfma_f32_16x16x32_bf16 v[152:155], a[120:123], a[168:171], v[152:155]
buffer_load_dwordx4 a[232:235], v218, s[20:23], s52 offen sc1
v_fmac_f32 v14, v147, v83
v_mfma_f32_16x16x32_bf16 v[152:155], a[124:127], a[172:175], v[152:155]
s_add_u32 s52, s52, 8388608
buffer_load_dwordx4 a[236:239], v218, s[20:23], s52 offen sc1
v_mfma_f32_16x16x32_bf16 v[156:159], a[128:131], a[160:163], 0
s_add_u32 s52, s43, 163840
v_fmac_f32 v1, v148, v84
v_fmac_f32 v2, v149, v85
v_mfma_f32_16x16x32_bf16 v[156:159], a[132:135], a[164:167], v[156:159]
buffer_load_dwordx4 a[240:243], v218, s[20:23], s52 offen sc1
v_fmac_f32 v13, v150, v86
v_mfma_f32_16x16x32_bf16 v[156:159], a[136:139], a[168:171], v[156:159]
s_add_u32 s52, s52, 8388608
v_fmac_f32 v14, v151, v87
v_mfma_f32_16x16x32_bf16 v[156:159], a[140:143], a[172:175], v[156:159]
buffer_load_dwordx4 a[244:247], v218, s[20:23], s52 offen sc1
s_add_u32 s52, s43, 196608
v_mfma_f32_16x16x32_bf16 v[144:147], a[144:147], a[160:163], 0
buffer_load_dwordx4 v[192:195], v218, s[20:23], s52 offen sc1
v_fmac_f32 v1, v152, v88
v_mfma_f32_16x16x32_bf16 v[144:147], a[148:151], a[164:167], v[144:147]
s_add_u32 s52, s52, 8388608
v_fmac_f32 v2, v153, v89
v_fmac_f32 v13, v154, v90
v_mfma_f32_16x16x32_bf16 v[144:147], a[152:155], a[168:171], v[144:147]
buffer_load_dwordx4 v[196:199], v218, s[20:23], s52 offen sc1
v_fmac_f32 v14, v155, v91
v_mfma_f32_16x16x32_bf16 v[144:147], a[156:159], a[172:175], v[144:147]
s_waitcnt vmcnt(15)
v_mfma_f32_16x16x32_bf16 v[148:151], a[160:163], a[160:163], 0
ds_read_b128 a[192:195], v136 offset:8192
v_fmac_f32 v1, v156, v92
v_mfma_f32_16x16x32_bf16 v[148:151], a[164:167], a[164:167], v[148:151]
ds_read_b128 a[196:199], v137 offset:8192
v_fmac_f32 v2, v157, v93
v_mfma_f32_16x16x32_bf16 v[148:151], a[168:171], a[168:171], v[148:151]
s_add_u32 s52, s43, 229376
v_fmac_f32 v13, v158, v94
v_fmac_f32 v14, v159, v95
v_mfma_f32_16x16x32_bf16 v[148:151], a[172:175], a[172:175], v[148:151]
buffer_load_dwordx4 v[200:203], v218, s[20:23], s52 offen sc1
s_add_u32 s52, s52, 8388608
buffer_load_dwordx4 v[204:207], v218, s[20:23], s52 offen sc1
s_waitcnt lgkmcnt(2)
v_mfma_f32_16x16x32_bf16 v[152:155], a[112:115], a[176:179], 0
ds_read_b128 a[200:203], v138 offset:8192
v_fmac_f32 v1, v144, v96
v_mfma_f32_16x16x32_bf16 v[152:155], a[116:119], a[180:183], v[152:155]
ds_read_b128 a[204:207], v139 offset:8192
v_fmac_f32 v2, v145, v97
v_mfma_f32_16x16x32_bf16 v[152:155], a[120:123], a[184:187], v[152:155]
s_waitcnt vmcnt(16)
v_fmac_f32 v13, v146, v98
v_fmac_f32 v14, v147, v99
v_mfma_f32_16x16x32_bf16 v[152:155], a[124:127], a[188:191], v[152:155]
ds_read_b128 a[208:211], v140 offset:8192
v_mfma_f32_16x16x32_bf16 v[156:159], a[128:131], a[176:179], 0
ds_read_b128 a[212:215], v141 offset:8192
v_fmac_f32 v1, v148, v100
v_mfma_f32_16x16x32_bf16 v[156:159], a[132:135], a[180:183], v[156:159]
ds_read_b128 a[216:219], v142 offset:8192
v_fmac_f32 v2, v149, v101
v_mfma_f32_16x16x32_bf16 v[156:159], a[136:139], a[184:187], v[156:159]
ds_read_b128 a[220:223], v143 offset:8192
v_fmac_f32 v13, v150, v102
v_mfma_f32_16x16x32_bf16 v[156:159], a[140:143], a[188:191], v[156:159]
v_fmac_f32 v14, v151, v103
v_mfma_f32_16x16x32_bf16 v[144:147], a[144:147], a[176:179], 0
v_fmac_f32 v1, v152, v104
v_fmac_f32 v2, v153, v105
v_mfma_f32_16x16x32_bf16 v[144:147], a[148:151], a[180:183], v[144:147]
v_fmac_f32 v13, v154, v106
v_fmac_f32 v14, v155, v107
v_mfma_f32_16x16x32_bf16 v[144:147], a[152:155], a[184:187], v[144:147]
v_mfma_f32_16x16x32_bf16 v[144:147], a[156:159], a[188:191], v[144:147]
v_mfma_f32_16x16x32_bf16 v[148:151], a[160:163], a[176:179], 0
v_fmac_f32 v1, v156, v108
v_mov_b64 v[224:225], 0
v_mfma_f32_16x16x32_bf16 v[148:151], a[164:167], a[180:183], v[148:151]
v_fmac_f32 v2, v157, v109
v_mov_b64 v[226:227], 0
v_mfma_f32_16x16x32_bf16 v[148:151], a[168:171], a[184:187], v[148:151]
s_waitcnt vmcnt(14)
v_fmac_f32 v13, v158, v110
s_nop 1
v_mfma_f32_16x16x32_bf16 v[148:151], a[172:175], a[188:191], v[148:151]
v_fmac_f32 v14, v159, v111
v_mfma_f32_16x16x32_bf16 v[152:155], a[176:179], a[176:179], 0
v_fmac_f32 v1, v144, v112
v_fmac_f32 v2, v145, v113
v_mfma_f32_16x16x32_bf16 v[152:155], a[180:183], a[180:183], v[152:155]
v_fmac_f32 v13, v146, v114
v_fmac_f32 v14, v147, v115
v_mfma_f32_16x16x32_bf16 v[152:155], a[184:187], a[184:187], v[152:155]
v_mfma_f32_16x16x32_bf16 v[152:155], a[188:191], a[188:191], v[152:155]
v_smfmac_f32_16x16x64_bf16 v[224:227], v[8:11], v[160:167], v12
s_waitcnt lgkmcnt(4)
v_mfma_f32_16x16x32_bf16 v[156:159], a[112:115], a[192:195], 0
v_fmac_f32 v1, v148, v116
v_mov_b64 v[228:229], 0
v_mfma_f32_16x16x32_bf16 v[156:159], a[116:119], a[196:199], v[156:159]
v_fmac_f32 v2, v149, v117
v_mov_b64 v[230:231], 0
v_mfma_f32_16x16x32_bf16 v[156:159], a[120:123], a[200:203], v[156:159]
s_waitcnt vmcnt(12)
v_fmac_f32 v13, v150, v118
s_nop 1
v_mfma_f32_16x16x32_bf16 v[156:159], a[124:127], a[204:207], v[156:159]
v_fmac_f32 v14, v151, v119
v_mfma_f32_16x16x32_bf16 v[144:147], a[128:131], a[192:195], 0
v_fmac_f32 v1, v152, v120
v_fmac_f32 v2, v153, v121
v_mfma_f32_16x16x32_bf16 v[144:147], a[132:135], a[196:199], v[144:147]
v_fmac_f32 v13, v154, v122
v_fmac_f32 v14, v155, v123
v_mfma_f32_16x16x32_bf16 v[144:147], a[136:139], a[200:203], v[144:147]
v_mfma_f32_16x16x32_bf16 v[144:147], a[140:143], a[204:207], v[144:147]
v_smfmac_f32_16x16x64_bf16 v[228:231], v[8:11], v[168:175], v12
v_mfma_f32_16x16x32_bf16 v[148:151], a[144:147], a[192:195], 0
v_fmac_f32 v1, v156, v124
v_mul_f32 v232, v224, v224
v_mfma_f32_16x16x32_bf16 v[148:151], a[148:151], a[196:199], v[148:151]
v_fmac_f32 v2, v157, v125
v_mul_f32 v233, v225, v225
v_mfma_f32_16x16x32_bf16 v[148:151], a[152:155], a[200:203], v[148:151]
v_fmac_f32 v13, v158, v126
v_mul_f32 v234, v226, v226
v_mfma_f32_16x16x32_bf16 v[148:151], a[156:159], a[204:207], v[148:151]
v_fmac_f32 v14, v159, v127
v_mul_f32 v235, v227, v227
v_mfma_f32_16x16x32_bf16 v[152:155], a[160:163], a[192:195], 0
v_fmac_f32 v1, v144, v16
v_fma_f32 v232, v232, s45, v219
v_mfma_f32_16x16x32_bf16 v[152:155], a[164:167], a[196:199], v[152:155]
v_fmac_f32 v2, v145, v17
v_fma_f32 v233, v233, s45, v219
v_mfma_f32_16x16x32_bf16 v[152:155], a[168:171], a[200:203], v[152:155]
v_fmac_f32 v13, v146, v18
v_fma_f32 v234, v234, s45, v219
v_mfma_f32_16x16x32_bf16 v[152:155], a[172:175], a[204:207], v[152:155]
v_fmac_f32 v14, v147, v19
v_fma_f32 v235, v235, s45, v219
v_mul_f32 v232, v232, v224
v_mul_f32 v233, v233, v225
v_mul_f32 v234, v234, v226
v_mul_f32 v235, v235, v227
v_exp_f32 v232, v232
v_exp_f32 v233, v233
v_exp_f32 v234, v234
v_exp_f32 v235, v235
v_add_f32 v232, 1.0, v232
v_add_f32 v233, 1.0, v233
v_add_f32 v234, 1.0, v234
v_add_f32 v235, 1.0, v235
v_rcp_f32 v232, v232
v_rcp_f32 v233, v233
v_rcp_f32 v234, v234
v_rcp_f32 v235, v235
v_mul_f32 v232, v232, v224
v_mul_f32 v233, v233, v225
v_mul_f32 v234, v234, v226
v_mul_f32 v235, v235, v227
v_cvt_pk_bf16_f32 v232, v232, v233
v_cvt_pk_bf16_f32 v233, v234, v235
v_dot2_f32_bf16 v4, v232, v240, v4
v_dot2_f32_bf16 v4, v233, v241, v4
v_mfma_f32_16x16x32_bf16 v[156:159], a[176:179], a[192:195], 0
v_fmac_f32 v1, v148, v20
v_mov_b64 v[224:225], 0
v_mfma_f32_16x16x32_bf16 v[156:159], a[180:183], a[196:199], v[156:159]
v_fmac_f32 v2, v149, v21
v_mov_b64 v[226:227], 0
v_mfma_f32_16x16x32_bf16 v[156:159], a[184:187], a[200:203], v[156:159]
s_waitcnt vmcnt(10)
v_fmac_f32 v13, v150, v22
s_nop 1
v_mfma_f32_16x16x32_bf16 v[156:159], a[188:191], a[204:207], v[156:159]
v_fmac_f32 v14, v151, v23
v_mfma_f32_16x16x32_bf16 v[144:147], a[192:195], a[192:195], 0
v_fmac_f32 v1, v152, v24
v_fmac_f32 v2, v153, v25
v_mfma_f32_16x16x32_bf16 v[144:147], a[196:199], a[196:199], v[144:147]
v_fmac_f32 v13, v154, v26
v_fmac_f32 v14, v155, v27
v_mfma_f32_16x16x32_bf16 v[144:147], a[200:203], a[200:203], v[144:147]
v_mfma_f32_16x16x32_bf16 v[144:147], a[204:207], a[204:207], v[144:147]
v_smfmac_f32_16x16x64_bf16 v[224:227], v[8:11], v[176:183], v12
s_waitcnt lgkmcnt(0)
v_mfma_f32_16x16x32_bf16 v[148:151], a[112:115], a[208:211], 0
v_fmac_f32 v1, v156, v28
v_mul_f32 v236, v228, v228
v_mfma_f32_16x16x32_bf16 v[148:151], a[116:119], a[212:215], v[148:151]
v_fmac_f32 v2, v157, v29
v_mul_f32 v237, v229, v229
v_mfma_f32_16x16x32_bf16 v[148:151], a[120:123], a[216:219], v[148:151]
v_fmac_f32 v13, v158, v30
v_mul_f32 v238, v230, v230
v_mfma_f32_16x16x32_bf16 v[148:151], a[124:127], a[220:223], v[148:151]
v_fmac_f32 v14, v159, v31
v_mul_f32 v239, v231, v231
v_mfma_f32_16x16x32_bf16 v[152:155], a[128:131], a[208:211], 0
v_fmac_f32 v1, v144, v32
v_fma_f32 v236, v236, s45, v219
v_mfma_f32_16x16x32_bf16 v[152:155], a[132:135], a[212:215], v[152:155]
v_fmac_f32 v2, v145, v33
v_fma_f32 v237, v237, s45, v219
v_mfma_f32_16x16x32_bf16 v[152:155], a[136:139], a[216:219], v[152:155]
v_fmac_f32 v13, v146, v34
v_fma_f32 v238, v238, s45, v219
v_mfma_f32_16x16x32_bf16 v[152:155], a[140:143], a[220:223], v[152:155]
v_fmac_f32 v14, v147, v35
v_fma_f32 v239, v239, s45, v219
v_mul_f32 v236, v236, v228
v_mul_f32 v237, v237, v229
v_mul_f32 v238, v238, v230
v_mul_f32 v239, v239, v231
v_exp_f32 v236, v236
v_exp_f32 v237, v237
v_exp_f32 v238, v238
v_exp_f32 v239, v239
v_add_f32 v236, 1.0, v236
v_add_f32 v237, 1.0, v237
v_add_f32 v238, 1.0, v238
v_add_f32 v239, 1.0, v239
v_rcp_f32 v236, v236
v_rcp_f32 v237, v237
v_rcp_f32 v238, v238
v_rcp_f32 v239, v239
v_mul_f32 v236, v236, v228
v_mul_f32 v237, v237, v229
v_mul_f32 v238, v238, v230
v_mul_f32 v239, v239, v231
v_cvt_pk_bf16_f32 v236, v236, v237
v_cvt_pk_bf16_f32 v237, v238, v239
v_dot2_f32_bf16 v4, v236, v242, v4
v_dot2_f32_bf16 v4, v237, v243, v4
v_mfma_f32_16x16x32_bf16 v[156:159], a[144:147], a[208:211], 0
v_fmac_f32 v1, v148, v36
v_mov_b64 v[228:229], 0
v_mfma_f32_16x16x32_bf16 v[156:159], a[148:151], a[212:215], v[156:159]
v_fmac_f32 v2, v149, v37
v_mov_b64 v[230:231], 0
v_mfma_f32_16x16x32_bf16 v[156:159], a[152:155], a[216:219], v[156:159]
s_waitcnt vmcnt(8)
v_fmac_f32 v13, v150, v38
s_nop 1
v_mfma_f32_16x16x32_bf16 v[156:159], a[156:159], a[220:223], v[156:159]
v_fmac_f32 v14, v151, v39
v_mfma_f32_16x16x32_bf16 v[144:147], a[160:163], a[208:211], 0
v_fmac_f32 v1, v152, v40
v_fmac_f32 v2, v153, v41
v_mfma_f32_16x16x32_bf16 v[144:147], a[164:167], a[212:215], v[144:147]
v_fmac_f32 v13, v154, v42
v_fmac_f32 v14, v155, v43
v_mfma_f32_16x16x32_bf16 v[144:147], a[168:171], a[216:219], v[144:147]
v_mfma_f32_16x16x32_bf16 v[144:147], a[172:175], a[220:223], v[144:147]
v_smfmac_f32_16x16x64_bf16 v[228:231], v[8:11], a[224:231], v12
v_mfma_f32_16x16x32_bf16 v[148:151], a[176:179], a[208:211], 0
v_fmac_f32 v1, v156, v44
v_mul_f32 v232, v224, v224
v_mfma_f32_16x16x32_bf16 v[148:151], a[180:183], a[212:215], v[148:151]
v_fmac_f32 v2, v157, v45
v_mul_f32 v233, v225, v225
v_mfma_f32_16x16x32_bf16 v[148:151], a[184:187], a[216:219], v[148:151]
v_fmac_f32 v13, v158, v46
v_mul_f32 v234, v226, v226
v_mfma_f32_16x16x32_bf16 v[148:151], a[188:191], a[220:223], v[148:151]
v_fmac_f32 v14, v159, v47
v_mul_f32 v235, v227, v227
v_mfma_f32_16x16x32_bf16 v[152:155], a[192:195], a[208:211], 0
v_fmac_f32 v1, v144, v48
v_fma_f32 v232, v232, s45, v219
v_mfma_f32_16x16x32_bf16 v[152:155], a[196:199], a[212:215], v[152:155]
v_fmac_f32 v2, v145, v49
v_fma_f32 v233, v233, s45, v219
v_mfma_f32_16x16x32_bf16 v[152:155], a[200:203], a[216:219], v[152:155]
v_fmac_f32 v13, v146, v50
v_fma_f32 v234, v234, s45, v219
v_mfma_f32_16x16x32_bf16 v[152:155], a[204:207], a[220:223], v[152:155]
v_fmac_f32 v14, v147, v51
v_fma_f32 v235, v235, s45, v219
v_mul_f32 v232, v232, v224
v_mul_f32 v233, v233, v225
v_mul_f32 v234, v234, v226
v_mul_f32 v235, v235, v227
v_exp_f32 v232, v232
v_exp_f32 v233, v233
v_exp_f32 v234, v234
v_exp_f32 v235, v235
v_add_f32 v232, 1.0, v232
v_add_f32 v233, 1.0, v233
v_add_f32 v234, 1.0, v234
v_add_f32 v235, 1.0, v235
v_rcp_f32 v232, v232
v_rcp_f32 v233, v233
v_rcp_f32 v234, v234
v_rcp_f32 v235, v235
v_mul_f32 v232, v232, v224
v_mul_f32 v233, v233, v225
v_mul_f32 v234, v234, v226
v_mul_f32 v235, v235, v227
v_cvt_pk_bf16_f32 v232, v232, v233
v_cvt_pk_bf16_f32 v233, v234, v235
v_dot2_f32_bf16 v4, v232, v244, v4
v_dot2_f32_bf16 v4, v233, v245, v4
v_mfma_f32_16x16x32_bf16 v[156:159], a[208:211], a[208:211], 0
v_fmac_f32 v1, v148, v52
v_mov_b64 v[224:225], 0
v_mfma_f32_16x16x32_bf16 v[156:159], a[212:215], a[212:215], v[156:159]
v_fmac_f32 v2, v149, v53
v_mov_b64 v[226:227], 0
v_mfma_f32_16x16x32_bf16 v[156:159], a[216:219], a[216:219], v[156:159]
s_waitcnt vmcnt(6)
v_fmac_f32 v13, v150, v54
s_nop 1
v_mfma_f32_16x16x32_bf16 v[156:159], a[220:223], a[220:223], v[156:159]
v_fmac_f32 v14, v151, v55
v_smfmac_f32_16x16x64_bf16 v[224:227], v[8:11], a[232:239], v12
v_mul_f32 v236, v228, v228
v_mul_f32 v237, v229, v229
v_mul_f32 v238, v230, v230
v_mul_f32 v239, v231, v231
v_fma_f32 v236, v236, s45, v219
v_fma_f32 v237, v237, s45, v219
v_fma_f32 v238, v238, s45, v219
v_fma_f32 v239, v239, s45, v219
v_mul_f32 v236, v236, v228
v_mul_f32 v237, v237, v229
v_mul_f32 v238, v238, v230
v_mul_f32 v239, v239, v231
v_exp_f32 v236, v236
v_exp_f32 v237, v237
v_exp_f32 v238, v238
v_exp_f32 v239, v239
v_add_f32 v236, 1.0, v236
v_add_f32 v237, 1.0, v237
v_add_f32 v238, 1.0, v238
v_add_f32 v239, 1.0, v239
v_rcp_f32 v236, v236
v_rcp_f32 v237, v237
v_rcp_f32 v238, v238
v_rcp_f32 v239, v239
v_mul_f32 v236, v236, v228
v_mul_f32 v237, v237, v229
v_mul_f32 v238, v238, v230
v_mul_f32 v239, v239, v231
v_cvt_pk_bf16_f32 v236, v236, v237
v_cvt_pk_bf16_f32 v237, v238, v239
v_dot2_f32_bf16 v4, v236, v246, v4
v_dot2_f32_bf16 v4, v237, v247, v4
v_mov_b64 v[228:229], 0
v_mov_b64 v[230:231], 0
s_waitcnt vmcnt(4)
s_nop 1
v_smfmac_f32_16x16x64_bf16 v[228:231], v[8:11], a[240:247], v12
v_mul_f32 v232, v224, v224
v_mul_f32 v233, v225, v225
v_mul_f32 v234, v226, v226
v_mul_f32 v235, v227, v227
v_fma_f32 v232, v232, s45, v219
v_fma_f32 v233, v233, s45, v219
v_fma_f32 v234, v234, s45, v219
v_fma_f32 v235, v235, s45, v219
v_mul_f32 v232, v232, v224
v_mul_f32 v233, v233, v225
v_mul_f32 v234, v234, v226
v_mul_f32 v235, v235, v227
v_exp_f32 v232, v232
v_exp_f32 v233, v233
v_exp_f32 v234, v234
v_exp_f32 v235, v235
v_add_f32 v232, 1.0, v232
v_add_f32 v233, 1.0, v233
v_add_f32 v234, 1.0, v234
v_add_f32 v235, 1.0, v235
v_rcp_f32 v232, v232
v_rcp_f32 v233, v233
v_rcp_f32 v234, v234
v_rcp_f32 v235, v235
v_mul_f32 v232, v232, v224
v_mul_f32 v233, v233, v225
v_mul_f32 v234, v234, v226
v_mul_f32 v235, v235, v227
v_cvt_pk_bf16_f32 v232, v232, v233
v_cvt_pk_bf16_f32 v233, v234, v235
v_dot2_f32_bf16 v4, v232, v248, v4
v_dot2_f32_bf16 v4, v233, v249, v4
v_mov_b64 v[224:225], 0
v_mov_b64 v[226:227], 0
s_waitcnt vmcnt(2)
s_nop 1
v_smfmac_f32_16x16x64_bf16 v[224:227], v[8:11], v[192:199], v12
v_mul_f32 v236, v228, v228
v_mul_f32 v237, v229, v229
v_mul_f32 v238, v230, v230
v_mul_f32 v239, v231, v231
v_fma_f32 v236, v236, s45, v219
v_fma_f32 v237, v237, s45, v219
v_fma_f32 v238, v238, s45, v219
v_fma_f32 v239, v239, s45, v219
v_mul_f32 v236, v236, v228
v_mul_f32 v237, v237, v229
v_mul_f32 v238, v238, v230
v_mul_f32 v239, v239, v231
v_exp_f32 v236, v236
v_exp_f32 v237, v237
v_exp_f32 v238, v238
v_exp_f32 v239, v239
v_add_f32 v236, 1.0, v236
v_add_f32 v237, 1.0, v237
v_add_f32 v238, 1.0, v238
v_add_f32 v239, 1.0, v239
v_rcp_f32 v236, v236
v_rcp_f32 v237, v237
v_rcp_f32 v238, v238
v_rcp_f32 v239, v239
v_mul_f32 v236, v236, v228
v_mul_f32 v237, v237, v229
v_mul_f32 v238, v238, v230
v_mul_f32 v239, v239, v231
v_cvt_pk_bf16_f32 v236, v236, v237
v_cvt_pk_bf16_f32 v237, v238, v239
v_dot2_f32_bf16 v4, v236, v250, v4
v_dot2_f32_bf16 v4, v237, v251, v4
v_mov_b64 v[228:229], 0
v_mov_b64 v[230:231], 0
s_waitcnt vmcnt(0)
s_nop 1
v_smfmac_f32_16x16x64_bf16 v[228:231], v[8:11], v[200:207], v12
v_mul_f32 v232, v224, v224
v_mul_f32 v233, v225, v225
v_mul_f32 v234, v226, v226
v_mul_f32 v235, v227, v227
v_fma_f32 v232, v232, s45, v219
v_fma_f32 v233, v233, s45, v219
v_fma_f32 v234, v234, s45, v219
v_fma_f32 v235, v235, s45, v219
v_mul_f32 v232, v232, v224
v_mul_f32 v233, v233, v225
v_mul_f32 v234, v234, v226
v_mul_f32 v235, v235, v227
v_exp_f32 v232, v232
v_exp_f32 v233, v233
v_exp_f32 v234, v234
v_exp_f32 v235, v235
v_add_f32 v232, 1.0, v232
v_add_f32 v233, 1.0, v233
v_add_f32 v234, 1.0, v234
v_add_f32 v235, 1.0, v235
v_rcp_f32 v232, v232
v_rcp_f32 v233, v233
v_rcp_f32 v234, v234
v_rcp_f32 v235, v235
v_mul_f32 v232, v232, v224
v_mul_f32 v233, v233, v225
v_mul_f32 v234, v234, v226
v_mul_f32 v235, v235, v227
v_cvt_pk_bf16_f32 v232, v232, v233
v_cvt_pk_bf16_f32 v233, v234, v235
v_dot2_f32_bf16 v4, v232, v252, v4
v_dot2_f32_bf16 v4, v233, v253, v4
s_nop 7
v_mul_f32 v236, v228, v228
v_mul_f32 v237, v229, v229
v_mul_f32 v238, v230, v230
v_mul_f32 v239, v231, v231
v_fma_f32 v236, v236, s45, v219
v_fma_f32 v237, v237, s45, v219
v_fma_f32 v238, v238, s45, v219
v_fma_f32 v239, v239, s45, v219
v_mul_f32 v236, v236, v228
v_mul_f32 v237, v237, v229
v_mul_f32 v238, v238, v230
v_mul_f32 v239, v239, v231
v_exp_f32 v236, v236
v_exp_f32 v237, v237
v_exp_f32 v238, v238
v_exp_f32 v239, v239
v_add_f32 v236, 1.0, v236
v_add_f32 v237, 1.0, v237
v_add_f32 v238, 1.0, v238
v_add_f32 v239, 1.0, v239
v_rcp_f32 v236, v236
v_rcp_f32 v237, v237
v_rcp_f32 v238, v238
v_rcp_f32 v239, v239
v_mul_f32 v236, v236, v228
v_mul_f32 v237, v237, v229
v_mul_f32 v238, v238, v230
v_mul_f32 v239, v239, v231
v_cvt_pk_bf16_f32 v236, v236, v237
v_cvt_pk_bf16_f32 v237, v238, v239
v_dot2_f32_bf16 v4, v236, v254, v4
v_dot2_f32_bf16 v4, v237, v255, v4
v_fmac_f32 v1, v152, v56
v_fmac_f32 v2, v153, v57
v_fmac_f32 v13, v154, v58
v_fmac_f32 v14, v155, v59
s_nop 7
v_fmac_f32 v1, v156, v60
v_fmac_f32 v2, v157, v61
v_fmac_f32 v13, v158, v62
v_fmac_f32 v14, v159, v63
v_add_f32 v1, v1, v2
v_add_f32 v13, v13, v14
v_add_f32 v1, v1, v13
v_accvgpr_write_b32 a255, v1
s_nop 1
v_accvgpr_read_b32 v64, a252
v_accvgpr_read_b32 v65, a253
v_accvgpr_read_b32 v66, a254
v_accvgpr_read_b32 v67, a255
s_nop 1
v_add_f32_dpp v64, v64, v64 row_ror:1 row_mask:0xf bank_mask:0xf
v_add_f32_dpp v65, v65, v65 row_ror:1 row_mask:0xf bank_mask:0xf
v_add_f32_dpp v66, v66, v66 row_ror:1 row_mask:0xf bank_mask:0xf
v_add_f32_dpp v67, v67, v67 row_ror:1 row_mask:0xf bank_mask:0xf
s_nop 1
v_add_f32_dpp v64, v64, v64 row_ror:2 row_mask:0xf bank_mask:0xf
v_add_f32_dpp v65, v65, v65 row_ror:2 row_mask:0xf bank_mask:0xf
v_add_f32_dpp v66, v66, v66 row_ror:2 row_mask:0xf bank_mask:0xf
v_add_f32_dpp v67, v67, v67 row_ror:2 row_mask:0xf bank_mask:0xf
s_nop 1
v_add_f32_dpp v64, v64, v64 row_ror:4 row_mask:0xf bank_mask:0xf
v_add_f32_dpp v65, v65, v65 row_ror:4 row_mask:0xf bank_mask:0xf
v_add_f32_dpp v66, v66, v66 row_ror:4 row_mask:0xf bank_mask:0xf
v_add_f32_dpp v67, v67, v67 row_ror:4 row_mask:0xf bank_mask:0xf
s_nop 1
v_add_f32_dpp v64, v64, v64 row_ror:8 row_mask:0xf bank_mask:0xf
v_add_f32_dpp v65, v65, v65 row_ror:8 row_mask:0xf bank_mask:0xf
v_add_f32_dpp v66, v66, v66 row_ror:8 row_mask:0xf bank_mask:0xf
v_add_f32_dpp v67, v67, v67 row_ror:8 row_mask:0xf bank_mask:0xf
v_lshrrev_b32 v68, 4, v7
v_lshlrev_b32 v68, 6, v68
s_lshl_b32 s44, s3, 4
s_add_u32 s44, s44, 162560
v_add_u32 v68, s44, v68
ds_write_b128 v68, v[64:67]
s_nop 1
v_add_f32_dpp v4, v4, v4 row_ror:8 row_mask:0xf bank_mask:0xf
v_mov_b32 v70, v4
s_nop 1
v_permlane32_swap_b32 v4, v70
v_add_f32 v4, v4, v70
v_and_b32 v68, 7, v7
v_lshlrev_b32 v68, 3, v68
v_bfe_u32 v70, v7, 4, 1
v_lshl_add_u32 v68, v70, 2, v68
s_lshl_b32 s44, s3, 6
s_add_u32 s44, s44, 162304
v_add_u32 v68, s44, v68
ds_write_b32 v68, v4
s_waitcnt lgkmcnt(0)
s_barrier
v_lshlrev_b32 v87, 2, v7
v_add_u32 v87, 162816, v87
ds_read_b32 v88, v87
s_cmp_lg_u32 s3, 0
s_cbranch_scc1 L_fin
v_and_b32 v84, 15, v7
v_lshlrev_b32 v85, 2, v84
v_add_u32 v85, 162304, v85
ds_read_b32 v90, v85 offset:0
ds_read_b32 v91, v85 offset:64
ds_read_b32 v92, v85 offset:128
ds_read_b32 v93, v85 offset:192
ds_read_b32 v94, v85 offset:256
ds_read_b32 v95, v85 offset:320
ds_read_b32 v96, v85 offset:384
ds_read_b32 v97, v85 offset:448
v_lshlrev_b32 v89, 16, v217
v_lshlrev_b32 v86, 1, v84
v_lshrrev_b32 v85, 4, v7
v_lshl_add_u32 v86, v85, 20, v86
s_waitcnt lgkmcnt(0)
v_readlane_b32 s43, v88, 8
v_add_f32 v89, v89, v90
v_add_f32 v89, v89, v91
v_add_f32 v89, v89, v92
v_add_f32 v89, v89, v93
v_add_f32 v89, v89, v94
v_add_f32 v89, v89, v95
v_add_f32 v89, v89, v96
v_add_f32 v89, v89, v97
s_lshl_b32 s43, s43, 20
s_lshl_b32 s44, s60, 5
s_add_u32 s44, s44, s43
v_cvt_pk_bf16_f32 v89, v89, v89
buffer_store_short v89, v86, s[32:35], s44 offen
L_fin:
s_waitcnt lgkmcnt(0)
v_cmp_ne_u32 vcc, 0, v88
s_nop 1
s_and_b32 s43, vcc_lo, 0xff
s_or_b32 s43, s43, s61
s_cmp_lg_u32 s43, 0
s_cbranch_scc1 L_fb3
L_fin2:
L_END:
s_endpgm
L_CODE_END:
L_fb_nona:
s_memrealtime s[42:43]
s_waitcnt lgkmcnt(0)
s_or_b32 s42, s42, 1
v_mov_b32 v48, s42
v_mov_b32 v49, 0
v_lshlrev_b32 v47, 20, v7
buffer_atomic_cmpswap v[48:49], v47, s[24:27], 0 offen sc0 sc1
s_waitcnt vmcnt(0)
v_readfirstlane_b32 s56, v48
s_nop 3
s_cmp_eq_u32 s56, 0
s_cselect_b32 s56, s42, s56
s_branch L_nonda
L_fb_nonb:
s_memrealtime s[42:43]
s_waitcnt lgkmcnt(0)
s_or_b32 s42, s42, 1
v_mov_b32 v48, s42
v_mov_b32 v49, 0
v_lshlrev_b32 v47, 20, v7
buffer_atomic_cmpswap v[48:49], v47, s[24:27], 0 offen sc0 sc1
s_waitcnt vmcnt(0)
v_readfirstlane_b32 s56, v48
s_nop 3
s_cmp_eq_u32 s56, 0
s_cselect_b32 s56, s42, s56
s_branch L_nondb
L_fb1:
s_waitcnt vmcnt(0) lgkmcnt(0)
s_mov_b32 s41, s37
s_mov_b32 s40, 0
L_fb1a:
s_mov_b32 s3, 0
L_fb1b:
s_lshl_b32 s42, s3, 2
v_bfe_u32 v148, v7, 2, 2
v_add_u32 v148, s42, v148
s_mul_i32 s42, s41, 96
s_lshl_b32 s43, s3, 6
s_add_u32 s42, s42, s43
v_lshl_add_u32 v144, v44, 2, s42
v_and_b32 v145, 3, v7
v_lshlrev_b32 v145, 2, v145
v_add_u32 v145, 384, v145
v_cmp_gt_u32 vcc, 6, v148
s_mul_i32 s43, s40, 64*400
s_nop 0
v_cndmask_b32 v144, v145, v144, vcc
v_lshrrev_b32 v145, 5, v7
v_lshlrev_b32 v145, 5, v145
v_bfe_u32 v149, v7, 4, 1
v_add_u32 v145, v145, v149
v_mul_u32_u24 v145, 400, v145
v_add_u32 v144, v144, v145
v_mov_b32 v145, 0x7ffffff0
v_cmp_gt_u32 vcc, 7, v148
s_nop 1
v_cndmask_b32 v144, v145, v144, vcc
buffer_load_dword v128, v144, s[4:7], s43 offen offset:0
buffer_load_dword v129, v144, s[4:7], s43 offen offset:800
buffer_load_dword v130, v144, s[4:7], s43 offen offset:1600
buffer_load_dword v131, v144, s[4:7], s43 offen offset:2400
s_add_u32 s43, s43, 3200
buffer_load_dword v132, v144, s[4:7], s43 offen offset:0
buffer_load_dword v133, v144, s[4:7], s43 offen offset:800
buffer_load_dword v134, v144, s[4:7], s43 offen offset:1600
buffer_load_dword v135, v144, s[4:7], s43 offen offset:2400
s_add_u32 s43, s43, 3200
buffer_load_dword v136, v144, s[4:7], s43 offen offset:0
buffer_load_dword v137, v144, s[4:7], s43 offen offset:800
buffer_load_dword v138, v144, s[4:7], s43 offen offset:1600
buffer_load_dword v139, v144, s[4:7], s43 offen offset:2400
s_add_u32 s43, s43, 3200
buffer_load_dword v140, v144, s[4:7], s43 offen offset:0
buffer_load_dword v141, v144, s[4:7], s43 offen offset:800
buffer_load_dword v142, v144, s[4:7], s43 offen offset:1600
buffer_load_dword v143, v144, s[4:7], s43 offen offset:2400
v_and_b32 v146, 3, v7
v_lshlrev_b32 v147, 6, v146
v_lshrrev_b32 v155, 2, v7
s_lshl_b32 s42, s3, 10
s_add_u32 s42, s42, 160256
v_lshl_add_u32 v149, v155, 6, s42
v_add_u32 v156, s42, v5
v_mov_b64 v[160:161], 0
v_mov_b64 v[162:163], 0
ds_write_b128 v156, v[160:163]
v_mul_u32_u24 v150, 0x010101, v146
v_lshl_or_b32 v150, v146, 24, v150
v_xor_b32 v150, 0x03020100, v150
v_cmp_gt_u32 vcc, 7, v148
v_mov_b32 v156, 0x4000
v_lshlrev_b32 v151, 2, v45
v_cndmask_b32 v155, v156, v148, vcc
v_lshl_add_u32 v151, v155, 9, v151
v_add_u32 v151, 156672, v151
v_xor_b32 v152, 0x100, v151
s_mov_b32 s62, 0x24100400
s_mov_b32 s63, 0x102
v_mov_b32 v153, 0x3c3c3c3c
v_mov_b32 v154, 0x101
v_xor_b32 v167, 1, v146
s_waitcnt vmcnt(0)
v_and_b32 v155, 7, v128
v_lshrrev_b32 v128, 2, v128
v_lshlrev_b32 v155, 4, v155
v_xor_b32 v155, v155, v147
v_lshl_add_u32 v128, v128, 8, v155
v_lshrrev_b32 v155, 2, v155
v_add_u32 v176, v155, v149
v_xor_b32 v157, 0, v146
v_lshlrev_b32 v158, 3, v157
v_lshlrev_b32 v158, v158, 1
ds_add_u32 v176, v158
v_mul_u32_u24 v157, v157, v154
v_bitop3_b32 v157, v157, s63, v151 bitop3:0x6a
ds_write_b16 v157, v128 offset:0
v_and_b32 v155, 7, v129
v_lshrrev_b32 v129, 2, v129
v_lshlrev_b32 v155, 4, v155
v_xor_b32 v155, v155, v147
v_lshl_add_u32 v129, v129, 8, v155
v_lshrrev_b32 v155, 2, v155
v_add_u32 v177, v155, v149
v_xor_b32 v165, 1, v146
v_lshlrev_b32 v166, 3, v165
v_lshlrev_b32 v166, v166, 1
ds_add_u32 v177, v166
v_mul_u32_u24 v165, v165, v154
v_bitop3_b32 v165, v165, s63, v151 bitop3:0x6a
ds_write_b16 v165, v129 offset:16
v_and_b32 v155, 7, v130
v_lshrrev_b32 v130, 2, v130
v_lshlrev_b32 v155, 4, v155
v_xor_b32 v155, v155, v147
v_lshl_add_u32 v130, v130, 8, v155
v_lshrrev_b32 v155, 2, v155
v_add_u32 v178, v155, v149
v_xor_b32 v157, 2, v146
v_lshlrev_b32 v158, 3, v157
v_lshlrev_b32 v158, v158, 1
ds_add_u32 v178, v158
v_mul_u32_u24 v157, v157, v154
v_bitop3_b32 v157, v157, s63, v151 bitop3:0x6a
ds_write_b16 v157, v130 offset:32
v_and_b32 v155, 7, v131
v_lshrrev_b32 v131, 2, v131
v_lshlrev_b32 v155, 4, v155
v_xor_b32 v155, v155, v147
v_lshl_add_u32 v131, v131, 8, v155
v_lshrrev_b32 v155, 2, v155
v_add_u32 v179, v155, v149
v_xor_b32 v165, 3, v146
v_lshlrev_b32 v166, 3, v165
v_lshlrev_b32 v166, v166, 1
ds_add_u32 v179, v166
v_mul_u32_u24 v165, v165, v154
v_bitop3_b32 v165, v165, s63, v151 bitop3:0x6a
ds_write_b16 v165, v131 offset:48
v_and_b32 v155, 7, v132
v_lshrrev_b32 v132, 2, v132
v_lshlrev_b32 v155, 4, v155
v_xor_b32 v155, v155, v147
v_lshl_add_u32 v132, v132, 8, v155
v_lshrrev_b32 v155, 2, v155
v_add_u32 v180, v155, v149
v_and_b32 v155, 7, v133
v_lshrrev_b32 v133, 2, v133
v_lshlrev_b32 v155, 4, v155
v_xor_b32 v155, v155, v147
v_lshl_add_u32 v133, v133, 8, v155
v_lshrrev_b32 v155, 2, v155
v_add_u32 v181, v155, v149
ds_read_b32 v156, v180
ds_read_b32 v164, v181
v_and_b32 v155, 7, v134
v_lshrrev_b32 v134, 2, v134
v_lshlrev_b32 v155, 4, v155
v_xor_b32 v155, v155, v147
v_lshl_add_u32 v134, v134, 8, v155
v_lshrrev_b32 v155, 2, v155
v_add_u32 v182, v155, v149
v_and_b32 v155, 7, v135
v_lshrrev_b32 v135, 2, v135
v_lshlrev_b32 v155, 4, v155
v_xor_b32 v155, v155, v147
v_lshl_add_u32 v135, v135, 8, v155
v_lshrrev_b32 v155, 2, v155
v_add_u32 v183, v155, v149
s_waitcnt lgkmcnt(0)
v_perm_b32 v156, v153, s62, v156
v_perm_b32 v164, v153, s62, v164
v_perm_b32 v156, v156, v156, v150
v_perm_b32 v164, v164, v164, v150
s_nop 0
v_add_u32_dpp v156, v156, v156 quad_perm:[1,0,3,2] row_mask:0xf bank_mask:0xf
v_add_u32_dpp v164, v164, v164 quad_perm:[1,0,3,2] row_mask:0xf bank_mask:0xf
s_nop 0
v_add_u32_dpp v156, v156, v156 quad_perm:[2,3,0,1] row_mask:0xf bank_mask:0xf
v_add_u32_dpp v164, v164, v164 quad_perm:[2,3,0,1] row_mask:0xf bank_mask:0xf
v_add_u32 v156, 50462976, v156
v_add_u32 v164, 33751041, v164
v_min_u32_sdwa v157, v156, v156 dst_sel:DWORD dst_unused:UNUSED_PAD src0_sel:BYTE_0 src1_sel:BYTE_1
v_min_u32_sdwa v165, v164, v164 dst_sel:DWORD dst_unused:UNUSED_PAD src0_sel:BYTE_0 src1_sel:BYTE_1
v_min_u32_sdwa v158, v156, v156 dst_sel:DWORD dst_unused:UNUSED_PAD src0_sel:BYTE_2 src1_sel:BYTE_3
v_min_u32_sdwa v166, v164, v164 dst_sel:DWORD dst_unused:UNUSED_PAD src0_sel:BYTE_2 src1_sel:BYTE_3
v_min_u32 v157, v157, v158
v_min_u32 v165, v165, v166
v_bitop3_b32 v157, v157, 3, v146 bitop3:0x6a
v_bitop3_b32 v165, v165, 3, v167 bitop3:0x6a
v_lshlrev_b32 v158, 3, v157
v_lshlrev_b32 v158, v158, 1
ds_add_u32 v180, v158
v_lshlrev_b32 v166, 3, v165
v_lshlrev_b32 v166, v166, 1
ds_add_u32 v181, v166
ds_read_b32 v156, v182
ds_read_b32 v164, v183
v_mul_u32_u24 v157, v157, v154
v_bitop3_b32 v157, v157, s63, v152 bitop3:0x6a
ds_write_b16 v157, v132 offset:64
v_mul_u32_u24 v165, v165, v154
v_bitop3_b32 v165, v165, s63, v152 bitop3:0x6a
ds_write_b16 v165, v133 offset:80
v_and_b32 v155, 7, v136
v_lshrrev_b32 v136, 2, v136
v_lshlrev_b32 v155, 4, v155
v_xor_b32 v155, v155, v147
v_lshl_add_u32 v136, v136, 8, v155
v_lshrrev_b32 v155, 2, v155
v_add_u32 v184, v155, v149
v_and_b32 v155, 7, v137
v_lshrrev_b32 v137, 2, v137
v_lshlrev_b32 v155, 4, v155
v_xor_b32 v155, v155, v147
v_lshl_add_u32 v137, v137, 8, v155
v_lshrrev_b32 v155, 2, v155
v_add_u32 v185, v155, v149
s_waitcnt lgkmcnt(2)
v_perm_b32 v156, v153, s62, v156
v_perm_b32 v164, v153, s62, v164
v_perm_b32 v156, v156, v156, v150
v_perm_b32 v164, v164, v164, v150
s_nop 0
v_add_u32_dpp v156, v156, v156 quad_perm:[1,0,3,2] row_mask:0xf bank_mask:0xf
v_add_u32_dpp v164, v164, v164 quad_perm:[1,0,3,2] row_mask:0xf bank_mask:0xf
s_nop 0
v_add_u32_dpp v156, v156, v156 quad_perm:[2,3,0,1] row_mask:0xf bank_mask:0xf
v_add_u32_dpp v164, v164, v164 quad_perm:[2,3,0,1] row_mask:0xf bank_mask:0xf
v_add_u32 v156, 50462976, v156
v_add_u32 v164, 33751041, v164
v_min_u32_sdwa v157, v156, v156 dst_sel:DWORD dst_unused:UNUSED_PAD src0_sel:BYTE_0 src1_sel:BYTE_1
v_min_u32_sdwa v165, v164, v164 dst_sel:DWORD dst_unused:UNUSED_PAD src0_sel:BYTE_0 src1_sel:BYTE_1
v_min_u32_sdwa v158, v156, v156 dst_sel:DWORD dst_unused:UNUSED_PAD src0_sel:BYTE_2 src1_sel:BYTE_3
v_min_u32_sdwa v166, v164, v164 dst_sel:DWORD dst_unused:UNUSED_PAD src0_sel:BYTE_2 src1_sel:BYTE_3
v_min_u32 v157, v157, v158
v_min_u32 v165, v165, v166
v_bitop3_b32 v157, v157, 3, v146 bitop3:0x6a
v_bitop3_b32 v165, v165, 3, v167 bitop3:0x6a
v_lshlrev_b32 v158, 3, v157
v_lshlrev_b32 v158, v158, 1
ds_add_u32 v182, v158
v_lshlrev_b32 v166, 3, v165
v_lshlrev_b32 v166, v166, 1
ds_add_u32 v183, v166
ds_read_b32 v156, v184
ds_read_b32 v164, v185
v_mul_u32_u24 v157, v157, v154
v_bitop3_b32 v157, v157, s63, v152 bitop3:0x6a
ds_write_b16 v157, v134 offset:96
v_mul_u32_u24 v165, v165, v154
v_bitop3_b32 v165, v165, s63, v152 bitop3:0x6a
ds_write_b16 v165, v135 offset:112
v_and_b32 v155, 7, v138
v_lshrrev_b32 v138, 2, v138
v_lshlrev_b32 v155, 4, v155
v_xor_b32 v155, v155, v147
v_lshl_add_u32 v138, v138, 8, v155
v_lshrrev_b32 v155, 2, v155
v_add_u32 v186, v155, v149
v_and_b32 v155, 7, v139
v_lshrrev_b32 v139, 2, v139
v_lshlrev_b32 v155, 4, v155
v_xor_b32 v155, v155, v147
v_lshl_add_u32 v139, v139, 8, v155
v_lshrrev_b32 v155, 2, v155
v_add_u32 v187, v155, v149
s_waitcnt lgkmcnt(2)
v_perm_b32 v156, v153, s62, v156
v_perm_b32 v164, v153, s62, v164
v_perm_b32 v156, v156, v156, v150
v_perm_b32 v164, v164, v164, v150
s_nop 0
v_add_u32_dpp v156, v156, v156 quad_perm:[1,0,3,2] row_mask:0xf bank_mask:0xf
v_add_u32_dpp v164, v164, v164 quad_perm:[1,0,3,2] row_mask:0xf bank_mask:0xf
s_nop 0
v_add_u32_dpp v156, v156, v156 quad_perm:[2,3,0,1] row_mask:0xf bank_mask:0xf
v_add_u32_dpp v164, v164, v164 quad_perm:[2,3,0,1] row_mask:0xf bank_mask:0xf
v_add_u32 v156, 50462976, v156
v_add_u32 v164, 33751041, v164
v_min_u32_sdwa v157, v156, v156 dst_sel:DWORD dst_unused:UNUSED_PAD src0_sel:BYTE_0 src1_sel:BYTE_1
v_min_u32_sdwa v165, v164, v164 dst_sel:DWORD dst_unused:UNUSED_PAD src0_sel:BYTE_0 src1_sel:BYTE_1
v_min_u32_sdwa v158, v156, v156 dst_sel:DWORD dst_unused:UNUSED_PAD src0_sel:BYTE_2 src1_sel:BYTE_3
v_min_u32_sdwa v166, v164, v164 dst_sel:DWORD dst_unused:UNUSED_PAD src0_sel:BYTE_2 src1_sel:BYTE_3
v_min_u32 v157, v157, v158
v_min_u32 v165, v165, v166
v_bitop3_b32 v157, v157, 3, v146 bitop3:0x6a
v_bitop3_b32 v165, v165, 3, v167 bitop3:0x6a
v_lshlrev_b32 v158, 3, v157
v_lshlrev_b32 v158, v158, 1
ds_add_u32 v184, v158
v_lshlrev_b32 v166, 3, v165
v_lshlrev_b32 v166, v166, 1
ds_add_u32 v185, v166
ds_read_b32 v156, v186
ds_read_b32 v164, v187
v_mul_u32_u24 v157, v157, v154
v_bitop3_b32 v157, v157, s63, v152 bitop3:0x6a
ds_write_b16 v157, v136 offset:128
v_mul_u32_u24 v165, v165, v154
v_bitop3_b32 v165, v165, s63, v152 bitop3:0x6a
ds_write_b16 v165, v137 offset:144
v_and_b32 v155, 7, v140
v_lshrrev_b32 v140, 2, v140
v_lshlrev_b32 v155, 4, v155
v_xor_b32 v155, v155, v147
v_lshl_add_u32 v140, v140, 8, v155
v_lshrrev_b32 v155, 2, v155
v_add_u32 v188, v155, v149
v_and_b32 v155, 7, v141
v_lshrrev_b32 v141, 2, v141
v_lshlrev_b32 v155, 4, v155
v_xor_b32 v155, v155, v147
v_lshl_add_u32 v141, v141, 8, v155
v_lshrrev_b32 v155, 2, v155
v_add_u32 v189, v155, v149
s_waitcnt lgkmcnt(2)
v_perm_b32 v156, v153, s62, v156
v_perm_b32 v164, v153, s62, v164
v_perm_b32 v156, v156, v156, v150
v_perm_b32 v164, v164, v164, v150
s_nop 0
v_add_u32_dpp v156, v156, v156 quad_perm:[1,0,3,2] row_mask:0xf bank_mask:0xf
v_add_u32_dpp v164, v164, v164 quad_perm:[1,0,3,2] row_mask:0xf bank_mask:0xf
s_nop 0
v_add_u32_dpp v156, v156, v156 quad_perm:[2,3,0,1] row_mask:0xf bank_mask:0xf
v_add_u32_dpp v164, v164, v164 quad_perm:[2,3,0,1] row_mask:0xf bank_mask:0xf
v_add_u32 v156, 50462976, v156
v_add_u32 v164, 33751041, v164
v_min_u32_sdwa v157, v156, v156 dst_sel:DWORD dst_unused:UNUSED_PAD src0_sel:BYTE_0 src1_sel:BYTE_1
v_min_u32_sdwa v165, v164, v164 dst_sel:DWORD dst_unused:UNUSED_PAD src0_sel:BYTE_0 src1_sel:BYTE_1
v_min_u32_sdwa v158, v156, v156 dst_sel:DWORD dst_unused:UNUSED_PAD src0_sel:BYTE_2 src1_sel:BYTE_3
v_min_u32_sdwa v166, v164, v164 dst_sel:DWORD dst_unused:UNUSED_PAD src0_sel:BYTE_2 src1_sel:BYTE_3
v_min_u32 v157, v157, v158
v_min_u32 v165, v165, v166
v_bitop3_b32 v157, v157, 3, v146 bitop3:0x6a
v_bitop3_b32 v165, v165, 3, v167 bitop3:0x6a
v_lshlrev_b32 v158, 3, v157
v_lshlrev_b32 v158, v158, 1
ds_add_u32 v186, v158
v_lshlrev_b32 v166, 3, v165
v_lshlrev_b32 v166, v166, 1
ds_add_u32 v187, v166
ds_read_b32 v156, v188
ds_read_b32 v164, v189
v_mul_u32_u24 v157, v157, v154
v_bitop3_b32 v157, v157, s63, v152 bitop3:0x6a
ds_write_b16 v157, v138 offset:160
v_mul_u32_u24 v165, v165, v154
v_bitop3_b32 v165, v165, s63, v152 bitop3:0x6a
ds_write_b16 v165, v139 offset:176
v_and_b32 v155, 7, v142
v_lshrrev_b32 v142, 2, v142
v_lshlrev_b32 v155, 4, v155
v_xor_b32 v155, v155, v147
v_lshl_add_u32 v142, v142, 8, v155
v_lshrrev_b32 v155, 2, v155
v_add_u32 v190, v155, v149
v_and_b32 v155, 7, v143
v_lshrrev_b32 v143, 2, v143
v_lshlrev_b32 v155, 4, v155
v_xor_b32 v155, v155, v147
v_lshl_add_u32 v143, v143, 8, v155
v_lshrrev_b32 v155, 2, v155
v_add_u32 v191, v155, v149
s_waitcnt lgkmcnt(2)
v_perm_b32 v156, v153, s62, v156
v_perm_b32 v164, v153, s62, v164
v_perm_b32 v156, v156, v156, v150
v_perm_b32 v164, v164, v164, v150
s_nop 0
v_add_u32_dpp v156, v156, v156 quad_perm:[1,0,3,2] row_mask:0xf bank_mask:0xf
v_add_u32_dpp v164, v164, v164 quad_perm:[1,0,3,2] row_mask:0xf bank_mask:0xf
s_nop 0
v_add_u32_dpp v156, v156, v156 quad_perm:[2,3,0,1] row_mask:0xf bank_mask:0xf
v_add_u32_dpp v164, v164, v164 quad_perm:[2,3,0,1] row_mask:0xf bank_mask:0xf
v_add_u32 v156, 50462976, v156
v_add_u32 v164, 33751041, v164
v_min_u32_sdwa v157, v156, v156 dst_sel:DWORD dst_unused:UNUSED_PAD src0_sel:BYTE_0 src1_sel:BYTE_1
v_min_u32_sdwa v165, v164, v164 dst_sel:DWORD dst_unused:UNUSED_PAD src0_sel:BYTE_0 src1_sel:BYTE_1
v_min_u32_sdwa v158, v156, v156 dst_sel:DWORD dst_unused:UNUSED_PAD src0_sel:BYTE_2 src1_sel:BYTE_3
v_min_u32_sdwa v166, v164, v164 dst_sel:DWORD dst_unused:UNUSED_PAD src0_sel:BYTE_2 src1_sel:BYTE_3
v_min_u32 v157, v157, v158
v_min_u32 v165, v165, v166
v_bitop3_b32 v157, v157, 3, v146 bitop3:0x6a
v_bitop3_b32 v165, v165, 3, v167 bitop3:0x6a
v_lshlrev_b32 v158, 3, v157
v_lshlrev_b32 v158, v158, 1
ds_add_u32 v188, v158
v_lshlrev_b32 v166, 3, v165
v_lshlrev_b32 v166, v166, 1
ds_add_u32 v189, v166
ds_read_b32 v156, v190
ds_read_b32 v164, v191
v_mul_u32_u24 v157, v157, v154
v_bitop3_b32 v157, v157, s63, v151 bitop3:0x6a
ds_write_b16 v157, v140 offset:192
v_mul_u32_u24 v165, v165, v154
v_bitop3_b32 v165, v165, s63, v151 bitop3:0x6a
ds_write_b16 v165, v141 offset:208
s_waitcnt lgkmcnt(2)
v_perm_b32 v156, v153, s62, v156
v_perm_b32 v164, v153, s62, v164
v_perm_b32 v156, v156, v156, v150
v_perm_b32 v164, v164, v164, v150
s_nop 0
v_add_u32_dpp v156, v156, v156 quad_perm:[1,0,3,2] row_mask:0xf bank_mask:0xf
v_add_u32_dpp v164, v164, v164 quad_perm:[1,0,3,2] row_mask:0xf bank_mask:0xf
s_nop 0
v_add_u32_dpp v156, v156, v156 quad_perm:[2,3,0,1] row_mask:0xf bank_mask:0xf
v_add_u32_dpp v164, v164, v164 quad_perm:[2,3,0,1] row_mask:0xf bank_mask:0xf
v_add_u32 v156, 50462976, v156
v_add_u32 v164, 33751041, v164
v_min_u32_sdwa v157, v156, v156 dst_sel:DWORD dst_unused:UNUSED_PAD src0_sel:BYTE_0 src1_sel:BYTE_1
v_min_u32_sdwa v165, v164, v164 dst_sel:DWORD dst_unused:UNUSED_PAD src0_sel:BYTE_0 src1_sel:BYTE_1
v_min_u32_sdwa v158, v156, v156 dst_sel:DWORD dst_unused:UNUSED_PAD src0_sel:BYTE_2 src1_sel:BYTE_3
v_min_u32_sdwa v166, v164, v164 dst_sel:DWORD dst_unused:UNUSED_PAD src0_sel:BYTE_2 src1_sel:BYTE_3
v_min_u32 v157, v157, v158
v_min_u32 v165, v165, v166
v_bitop3_b32 v157, v157, 3, v146 bitop3:0x6a
v_bitop3_b32 v165, v165, 3, v167 bitop3:0x6a
v_lshlrev_b32 v158, 3, v157
v_lshlrev_b32 v158, v158, 1
ds_add_u32 v190, v158
v_lshlrev_b32 v166, 3, v165
v_lshlrev_b32 v166, v166, 1
ds_add_u32 v191, v166
v_mul_u32_u24 v157, v157, v154
v_bitop3_b32 v157, v157, s63, v151 bitop3:0x6a
ds_write_b16 v157, v142 offset:224
v_mul_u32_u24 v165, v165, v154
v_bitop3_b32 v165, v165, s63, v151 bitop3:0x6a
ds_write_b16 v165, v143 offset:240
s_waitcnt lgkmcnt(0)
s_lshl_b32 s42, s3, 11
s_add_u32 s42, s42, 156672
v_add_u32 v144, s42, v5
ds_read_b128 v[128:131], v144 offset:0
ds_read_b128 v[132:135], v144 offset:1024
s_lshr_b32 s42, s40, 4
s_lshl_b32 s43, s41, 2
s_add_u32 s42, s42, s43
s_mul_i32 s42, s42, 50
s_lshr_b32 s43, s40, 1
s_lshl_b32 s44, s41, 1
s_sub_u32 s43, s43, s44
s_sub_u32 s43, s43, 2
s_and_b32 s43, s43, 7
s_add_u32 s42, s42, s43
s_lshl_b32 s42, s42, 10
s_and_b32 s44, s40, 1
s_lshl_b32 s44, s44, 9
s_add_u32 s42, s42, s44
s_lshl_b32 s44, s3, 15
s_add_u32 s42, s42, s44
v_and_b32 v145, 31, v7
v_lshlrev_b32 v145, 4, v145
v_lshrrev_b32 v146, 5, v7
v_lshl_add_u32 v145, v146, 13, v145
s_cmp_ge_u32 s43, 6
s_cselect_b32 s44, 32, 0
s_cmp_eq_u32 s3, 0
s_cselect_b32 s44, 64, s44
s_cselect_b32 s43, 0, 6144
v_cmp_gt_u32 vcc, s44, v7
v_mov_b32 v146, 0x7ffffff0
s_waitcnt lgkmcnt(0)
v_cndmask_b32 v146, v146, v145, vcc
buffer_store_dwordx4 v[128:131], v145, s[16:19], s42 offen sc1
s_add_u32 s42, s42, 16384
s_sub_u32 s42, s42, s43
buffer_store_dwordx4 v[132:135], v146, s[16:19], s42 offen sc1
s_waitcnt vmcnt(0) lgkmcnt(0)
s_add_u32 s3, s3, 1
s_cmp_lt_u32 s3, 2
s_cbranch_scc1 L_fb1b
L_fb1e:
s_cmp_lt_u32 s3, 2
s_cbranch_scc1 L_fb1c
s_and_b32 s52, s3, 1
s_lshl_b32 s52, s52, 6
s_add_u32 s52, s52, s40
s_lshr_b32 s44, s52, 2
s_mov_b32 s43, 0
s_cmp_ge_u32 s44, 1
s_cselect_b32 s43, 1, s43
s_cmp_ge_u32 s44, 3
s_cselect_b32 s43, 2, s43
s_cmp_ge_u32 s44, 6
s_cselect_b32 s43, 3, s43
s_cmp_ge_u32 s44, 10
s_cselect_b32 s43, 4, s43
s_cmp_ge_u32 s44, 15
s_cselect_b32 s43, 5, s43
s_cmp_ge_u32 s44, 21
s_cselect_b32 s43, 6, s43
s_cmp_ge_u32 s44, 28
s_cselect_b32 s43, 7, s43
s_add_u32 s42, s43, 1
s_mul_i32 s42, s42, s43
s_lshr_b32 s42, s42, 1
s_sub_u32 s42, s44, s42
s_cmp_eq_u32 s42, s43
s_cselect_b32 s44, 0x100000, 0
s_lshl_b32 s42, s42, 2
s_and_b32 s57, s52, 3
s_add_u32 s42, s42, s57
v_bfe_u32 v32, v7, 2, 2
v_mul_u32_u24 v32, 25, v32
v_lshl_add_u32 v33, s43, 2, v45
v_add_u32 v32, v32, v33
v_and_b32 v34, 3, v7
v_mul_u32_u24 v34, 25, v34
v_add_u32 v34, s42, v34
v_max_u32 v33, s42, v33
v_cmp_gt_u32 vcc, 25, v33
v_mul_u32_u24 v33, 100, v34
v_add_lshl_u32 v33, v33, v32, 1
v_mul_u32_u24 v35, 100, v32
v_add_lshl_u32 v35, v35, v34, 1
v_mov_b32 v32, 0x7ff00000
v_cndmask_b32 v33, v32, v33, vcc
v_cndmask_b32 v35, v32, v35, vcc
s_mov_b32 s28, s68
s_mov_b32 s29, s69
s_mov_b32 s30, 20000
s_mov_b32 s31, 0x20000
buffer_load_ushort v36, v33, s[28:31], 0 offen
buffer_load_ushort v37, v35, s[28:31], s44 offen
s_mov_b32 s57, s52
L_fb1c:
s_cmp_lt_u32 s3, 2
s_cbranch_scc1 L_fb1d
s_add_u32 s28, s82, 1114112
s_addc_u32 s29, s83, 0
s_mov_b32 s30, 131072
s_mov_b32 s31, 0x20000
s_lshl_b32 s44, s41, 15
s_lshl_b32 s43, s57, 8
s_add_u32 s44, s44, s43
v_lshlrev_b32 v38, 2, v7
s_waitcnt vmcnt(0)
v_lshlrev_b32 v36, 16, v36
v_lshlrev_b32 v37, 16, v37
v_add_f32 v36, v36, v37
buffer_store_dword v36, v38, s[28:31], s44 offen sc1
L_fb1d:
s_waitcnt vmcnt(0)
s_add_u32 s3, s3, 1
s_cmp_lt_u32 s3, 4
s_cbranch_scc1 L_fb1e
s_add_u32 s40, s40, 1
s_cmp_lt_u32 s40, 64
s_cbranch_scc1 L_fb1a
s_mov_b32 s3, 1
s_lshl_b32 s43, s37, 10
v_mov_b32 v52, s56
v_mov_b32 v53, s56
v_mov_b32 v54, s56
v_mov_b32 v55, s56
buffer_store_dwordx4 v[52:55], v5, s[32:35], s43 offen sc1
v_mov_b64 v[128:129], v[28:29]
v_mov_b64 v[130:131], v[30:31]
v_mov_b64 v[132:133], v[28:29]
v_mov_b64 v[134:135], v[30:31]
v_mov_b64 v[136:137], v[28:29]
v_mov_b64 v[138:139], v[30:31]
v_mov_b64 v[140:141], v[28:29]
v_mov_b64 v[142:143], v[30:31]
v_mov_b64 v[144:145], v[28:29]
v_mov_b64 v[146:147], v[30:31]
v_mov_b64 v[148:149], v[28:29]
v_mov_b64 v[150:151], v[30:31]
v_mov_b64 v[152:153], v[28:29]
v_mov_b64 v[154:155], v[30:31]
v_mov_b64 v[156:157], v[28:29]
v_mov_b64 v[158:159], v[30:31]
v_mov_b64 v[160:161], v[28:29]
v_mov_b64 v[162:163], v[30:31]
v_mov_b64 v[164:165], v[28:29]
v_mov_b64 v[166:167], v[30:31]
v_mov_b64 v[168:169], v[28:29]
v_mov_b64 v[170:171], v[30:31]
v_mov_b64 v[172:173], v[28:29]
v_mov_b64 v[174:175], v[30:31]
v_mov_b64 v[176:177], v[28:29]
v_mov_b64 v[178:179], v[30:31]
v_mov_b64 v[180:181], v[28:29]
v_mov_b64 v[182:183], v[30:31]
v_mov_b64 v[184:185], v[28:29]
v_mov_b64 v[186:187], v[30:31]
v_mov_b64 v[188:189], v[28:29]
v_mov_b64 v[190:191], v[30:31]
s_waitcnt vmcnt(0)
s_branch L_poll1d
L_fb2:
s_waitcnt vmcnt(0)
s_and_b32 s42, s2, 31
s_lshl_b32 s42, 1, s42
s_lshr_b32 s44, s2, 5
s_lshl_b32 s44, s44, 2
v_mov_b32 v220, s42
v_lshlrev_b32 v221, 20, v7
buffer_atomic_or v220, v221, s[24:27], s44 offen offset:32 sc0 sc1
s_waitcnt vmcnt(0)
buffer_load_dword v220, v5, s[12:15], 0 offen offset:0 sc1
buffer_load_dword v221, v5, s[12:15], 0 offen offset:1024 sc1
buffer_load_dword v222, v5, s[12:15], 0 offen offset:2048 sc1
buffer_load_dword v223, v5, s[12:15], 0 offen offset:3072 sc1
buffer_load_dword v232, v233, s[24:27], 0 offen offset:32 sc1
s_waitcnt vmcnt(0)
v_xor_b32 v220, s56, v220
v_xor_b32 v221, s56, v221
v_xor_b32 v222, s56, v222
v_xor_b32 v223, s56, v223
v_or3_b32 v220, v220, v221, v222
v_or_b32 v220, v220, v223
v_cmp_eq_u32 vcc, 0, v220
s_nop 1
s_cmp_eq_u64 vcc, -1
s_cbranch_scc1 L_poll2k
s_mov_b32 s43, 1
v_mov_b32 v232, 0
s_branch L_poll2k
L_fb3:
s_cmp_lg_u32 s61, 0
s_cbranch_scc1 L_fb3a
v_accvgpr_write_b32 a250, v88
s_mov_b32 s61, 1
L_fb3a:
s_nop 1
v_accvgpr_read_b32 v88, a250
s_nop 1
v_cmp_ne_u32 vcc, 0, v88
s_nop 1
s_and_b32 s43, vcc_lo, 0xff
s_cmp_eq_u32 s43, 0
s_cbranch_scc1 L_fin2
s_ff1_i32_b32 s43, s43
s_nop 3
v_readlane_b32 s44, v88, s43
s_nop 3
s_ff1_i32_b32 s42, s44
s_bitset0_b32 s44, s42
s_mov_b32 m0, s43
s_nop 3
v_writelane_b32 v88, s44, m0
s_lshl_b32 s60, s43, 5
s_add_u32 s60, s60, s42
s_nop 1
v_accvgpr_write_b32 a250, v88
s_waitcnt vmcnt(0) lgkmcnt(0)
s_barrier
s_lshl_b32 s59, s60, 4
s_lshl_b32 s44, s3, 2
s_add_u32 s59, s59, s44
s_mul_i32 s59, s59, 400
s_mov_b32 s22, 0
buffer_load_dwordx4 v[160:163], v15, s[4:7], s59 offen offset:0
buffer_load_dwordx4 v[164:167], v15, s[4:7], s59 offen offset:16
buffer_load_dwordx4 v[168:171], v15, s[4:7], s59 offen offset:32
buffer_load_dwordx4 v[172:175], v15, s[4:7], s59 offen offset:48
buffer_load_dwordx4 v[176:179], v15, s[4:7], s59 offen offset:64
buffer_load_dwordx4 v[180:183], v15, s[4:7], s59 offen offset:80
buffer_load_dword v184, v15, s[4:7], s59 offen offset:96
buffer_load_dwordx4 v[188:191], v15, s[4:7], s59 offen offset:400
buffer_load_dwordx4 v[192:195], v15, s[4:7], s59 offen offset:416
buffer_load_dwordx4 v[196:199], v15, s[4:7], s59 offen offset:432
buffer_load_dwordx4 v[200:203], v15, s[4:7], s59 offen offset:448
buffer_load_dwordx4 v[204:207], v15, s[4:7], s59 offen offset:464
buffer_load_dwordx4 v[208:211], v15, s[4:7], s59 offen offset:480
buffer_load_dword v212, v15, s[4:7], s59 offen offset:496
ds_read_b128 v[64:67], v3 offset:0
ds_read_b128 v[68:71], v3 offset:1024
ds_read_b128 v[72:75], v3 offset:2048
ds_read_b128 v[76:79], v3 offset:3072
ds_read_b128 v[80:83], v3 offset:4096
ds_read_b128 v[84:87], v3 offset:5120
ds_read_b128 v[88:91], v3 offset:6144
ds_read_b128 v[92:95], v3 offset:7168
ds_read_b128 v[96:99], v3 offset:8192
ds_read_b128 v[100:103], v3 offset:9216
ds_read_b128 v[104:107], v3 offset:10240
ds_read_b128 v[108:111], v3 offset:11264
ds_read_b128 v[112:115], v3 offset:12288
ds_read_b128 v[116:119], v3 offset:13312
ds_read_b128 v[120:123], v3 offset:14336
ds_read_b128 v[124:127], v3 offset:15360
s_waitcnt vmcnt(13)
s_add_u32 m0, s57, 12288
v_lshl_add_u32 v160, v160, 8, v128
buffer_load_dwordx4 v160, s[8:11], 0 offen offset:0 lds
v_lshl_add_u32 v161, v161, 8, v129
buffer_load_dwordx4 v161, s[8:11], 0 offen offset:1024 lds
v_lshl_add_u32 v162, v162, 8, v130
buffer_load_dwordx4 v162, s[8:11], 0 offen offset:2048 lds
v_lshl_add_u32 v163, v163, 8, v131
buffer_load_dwordx4 v163, s[8:11], 0 offen offset:3072 lds
s_waitcnt vmcnt(16)
s_add_u32 m0, s57, 8192
v_lshl_add_u32 v164, v164, 8, v128
buffer_load_dwordx4 v164, s[8:11], 0 offen offset:0 lds
v_lshl_add_u32 v165, v165, 8, v129
buffer_load_dwordx4 v165, s[8:11], 0 offen offset:1024 lds
v_lshl_add_u32 v166, v166, 8, v130
buffer_load_dwordx4 v166, s[8:11], 0 offen offset:2048 lds
v_lshl_add_u32 v167, v167, 8, v131
buffer_load_dwordx4 v167, s[8:11], 0 offen offset:3072 lds
s_waitcnt vmcnt(19)
s_add_u32 m0, s57, 4096
v_lshl_add_u32 v168, v168, 8, v128
buffer_load_dwordx4 v168, s[8:11], 0 offen offset:0 lds
v_lshl_add_u32 v169, v169, 8, v129
buffer_load_dwordx4 v169, s[8:11], 0 offen offset:1024 lds
v_lshl_add_u32 v170, v170, 8, v130
buffer_load_dwordx4 v170, s[8:11], 0 offen offset:2048 lds
v_lshl_add_u32 v171, v171, 8, v131
buffer_load_dwordx4 v171, s[8:11], 0 offen offset:3072 lds
s_waitcnt vmcnt(22)
s_add_u32 m0, s57, 0
v_lshl_add_u32 v172, v172, 8, v128
buffer_load_dwordx4 v172, s[8:11], 0 offen offset:0 lds
v_lshl_add_u32 v173, v173, 8, v129
buffer_load_dwordx4 v173, s[8:11], 0 offen offset:1024 lds
v_lshl_add_u32 v174, v174, 8, v130
buffer_load_dwordx4 v174, s[8:11], 0 offen offset:2048 lds
v_lshl_add_u32 v175, v175, 8, v131
buffer_load_dwordx4 v175, s[8:11], 0 offen offset:3072 lds
s_waitcnt vmcnt(12)
ds_read_b128 a[0:3], v132 offset:12288
ds_read_b128 a[4:7], v133 offset:12288
ds_read_b128 a[8:11], v134 offset:12288
ds_read_b128 a[12:15], v135 offset:12288
s_waitcnt vmcnt(8)
ds_read_b128 a[16:19], v132 offset:8192
ds_read_b128 a[20:23], v133 offset:8192
s_waitcnt vmcnt(0) lgkmcnt(0)
s_branch L_RERUN
.section .rodata,"a"
.p2align 6
.amdhsa_kernel standalone__deep_cross_pnn__recsys_kernel
  .amdhsa_next_free_vgpr 512
  .amdhsa_next_free_sgpr 102
  .amdhsa_accum_offset 256
  .amdhsa_group_segment_fixed_size 0
  .amdhsa_kernarg_size 80
  .amdhsa_user_sgpr_count 2
  .amdhsa_user_sgpr_kernarg_segment_ptr 1
  .amdhsa_system_sgpr_workgroup_id_x 1
  .amdhsa_float_denorm_mode_32 3
.end_amdhsa_kernel
```
